```python
import torch

def _softmax(x, axis=-1):
    return torch.softmax(x, dim=axis)
def _gelu(x):
    return torch.nn.functional.gelu(x, approximate="tanh")
def _silu(x):
    return torch.nn.functional.silu(x)
def _sigmoid(x):
    return torch.sigmoid(x)
def _layernorm(x, axis=-1, eps=1e-5):
    m = x.mean(dim=axis, keepdim=True)
    v = x.var(dim=axis, keepdim=True, unbiased=False)
    return (x - m) / torch.sqrt(v + eps)
def _scatter_add(tgt, idx, src, axis=0):
    return tgt.clone().index_add_(axis, idx, src)
def _segment_sum(src, seg, n):
    out = torch.zeros((n,) + src.shape[1:], dtype=src.dtype)
    return out.index_add_(0, seg, src)
def _pad(x, pw):
    flat = tuple(v for pair in reversed(pw) for v in pair)
    return torch.nn.functional.pad(x, flat)

kernel_name = 'interleave_layers__spectral_fnet__dense_activation_squared_relu__prompt'

def setup_inputs():

    _w = (lambda a: (lambda t: t.to(torch.bfloat16) if t.is_floating_point() else t)(torch.as_tensor(a)))
    def _A_setup():
        B, S, D = 1, 2048, 512
        ns = torch.arange(S)[:, None] * torch.arange(S)[None, :]
        nd = torch.arange(D)[:, None] * torch.arange(D)[None, :]
        Ws_re = torch.cos(-2.0 * torch.pi * ns / S).to(float)
        Ws_im = torch.sin(-2.0 * torch.pi * ns / S).to(float)
        Wd_re = torch.cos(-2.0 * torch.pi * nd / D).to(float)
        Wd_im = torch.sin(-2.0 * torch.pi * nd / D).to(float)
        return {
            "x": _w((lambda *s: torch.randn(*s, dtype=torch.bfloat16) * 0.05)(B, S, D)),
            "dft_seq_re": _w(Ws_re),
            "dft_seq_im": _w(Ws_im),
            "dft_hid_re": _w(Wd_re),
            "dft_hid_im": _w(Wd_im),
        }
    _A_in = _A_setup()

    def _B_setup():
        B, S, D, F = 1, 2048, 512, 1792
        return {
            "x": _w((lambda *s: torch.randn(*s, dtype=torch.bfloat16) * 0.05)(B, S, D)),
            "w1": _w((lambda *s: torch.randn(*s, dtype=torch.bfloat16) * 0.4)(D, F)),
            "b1": _w((lambda *s: torch.randn(*s, dtype=torch.bfloat16) * 0.4)(F)),
            "w2": _w((lambda *s: torch.randn(*s, dtype=torch.bfloat16) * 0.4)(F, D)),
            "b2": _w((lambda *s: torch.randn(*s, dtype=torch.bfloat16) * 0.4)(D)),
        }
    _B_in = _B_setup()

    return {
        "A_x": _A_in["x"],
        "A_dft_seq_re": _A_in["dft_seq_re"],
        "A_dft_seq_im": _A_in["dft_seq_im"],
        "A_dft_hid_re": _A_in["dft_hid_re"],
        "A_dft_hid_im": _A_in["dft_hid_im"],
        "B_x": _B_in["x"],
        "B_w1": _B_in["w1"],
        "B_b1": _B_in["b1"],
        "B_w2": _B_in["w2"],
        "B_b2": _B_in["b2"],
    }

def reference(A_x, A_dft_seq_re, A_dft_seq_im, A_dft_hid_re, A_dft_hid_im, B_x, B_w1, B_b1, B_w2, B_b2):
    def _A_ref(x, dft_seq_re, dft_seq_im, dft_hid_re, dft_hid_im):
        a = torch.einsum("bsd,ed->bse", x, dft_hid_re)
        b = torch.einsum("bsd,ed->bse", x, dft_hid_im)
        y = torch.einsum("ts,bse->bte", dft_seq_re, a) - torch.einsum("ts,bse->bte", dft_seq_im, b)
        return y

    def _B_ref(x, w1, b1, w2, b2):
        h = torch.einsum("bsd,df->bsf", x, w1) + b1
        zero = torch.zeros_like(h)
        r = torch.where(h > zero, h, zero)
        h = r * r
        out = torch.einsum("bsf,fd->bsd", h, w2) + b2
        return out

    x = A_x
    x = x + _A_ref(_layernorm(x, axis=-1), A_dft_seq_re, A_dft_seq_im, A_dft_hid_re, A_dft_hid_im)
    x = x + _B_ref(_layernorm(x, axis=-1), B_w1, B_b1, B_w2, B_b2)
    x = x + _A_ref(_layernorm(x, axis=-1), A_dft_seq_re, A_dft_seq_im, A_dft_hid_re, A_dft_hid_im)
    x = x + _B_ref(_layernorm(x, axis=-1), B_w1, B_b1, B_w2, B_b2)
    return x
```

```asm
; @launch kernel=ln0_kernel grid=(624,1,1) block=(256,1,1) lds=0
; @launch kernel=p1_kernel grid=(256,1,1) block=(256,1,1) lds=122880
; @launch kernel=p2_kernel grid=(256,1,1) block=(256,1,1) lds=122880
; @launch kernel=comb_kernel grid=(512,1,1) block=(256,1,1) lds=0
; @launch kernel=p3_kernel grid=(224,1,1) block=(256,1,1) lds=131072
; @launch kernel=p4_kernel grid=(256,1,1) block=(256,1,1) lds=98304
; @launch kernel=ln_kernel grid=(512,1,1) block=(256,1,1) lds=0
; @launch kernel=p1_kernel grid=(256,1,1) block=(256,1,1) lds=122880
; @launch kernel=p2_kernel grid=(256,1,1) block=(256,1,1) lds=122880
; @launch kernel=comb_kernel grid=(512,1,1) block=(256,1,1) lds=0
; @launch kernel=p3_kernel grid=(224,1,1) block=(256,1,1) lds=131072
; @launch kernel=p4_kernel grid=(256,1,1) block=(256,1,1) lds=98304
.amdgcn_target "amdgcn-amd-amdhsa--gfx950"
.text
.globl ln0_kernel
.p2align 8
.type ln0_kernel,@function
ln0_kernel:
    s_cmp_ge_u32 s2, 624
    s_cbranch_scc1 ln0_kernel_end
    s_load_dwordx16 s[36:51], s[0:1], 0
    s_load_dwordx8 s[52:59], s[0:1], 64
    s_load_dwordx2 s[60:61], s[0:1], 96
    v_and_b32 v1, 63, v0
    v_lshrrev_b32 v2, 6, v0
    s_nop 0
    v_readfirstlane_b32 s26, v2
    s_nop 1
    s_cmp_ge_u32 s2, 512
    s_cbranch_scc1 ln0_kernel_tr
    s_lshl_b32 s27, s2, 2
    s_add_u32 s27, s27, s26
    s_lshl_b32 s28, s27, 10
    v_lshlrev_b32 v3, 4, v1
    s_waitcnt lgkmcnt(0)
    s_mov_b32 s4, s36
    s_mov_b32 s5, s37
    s_mov_b32 s6, 2097152
    s_mov_b32 s7, 0x00020000
    s_mov_b32 s8, s56
    s_mov_b32 s9, s57
    s_mov_b32 s10, 2097152
    s_mov_b32 s11, 0x00020000
    s_add_u32 s12, s60, 4194304
    s_addc_u32 s13, s61, 0
    s_mov_b32 s14, 2097152
    s_mov_b32 s15, 0x00020000
    buffer_load_dwordx4 v[4:7], v3, s[4:7], s28 offen
    s_waitcnt vmcnt(0)
    buffer_store_dwordx4 v[4:7], v3, s[8:11], s28 offen
    v_lshlrev_b32 v8, 16, v4
    v_and_b32 v9, 0xffff0000, v4
    v_lshlrev_b32 v10, 16, v5
    v_and_b32 v11, 0xffff0000, v5
    v_lshlrev_b32 v12, 16, v6
    v_and_b32 v13, 0xffff0000, v6
    v_lshlrev_b32 v14, 16, v7
    v_and_b32 v15, 0xffff0000, v7
    v_add_f32 v24, v8, v9
    v_add_f32 v24, v24, v10
    v_add_f32 v24, v24, v11
    v_add_f32 v24, v24, v12
    v_add_f32 v24, v24, v13
    v_add_f32 v24, v24, v14
    v_add_f32 v24, v24, v15
    s_nop 1
    v_add_f32_dpp v25, v24, v24 row_ror:8 row_mask:0xf bank_mask:0xf
    s_nop 1
    v_add_f32_dpp v24, v25, v25 row_ror:4 row_mask:0xf bank_mask:0xf
    s_nop 1
    v_add_f32_dpp v25, v24, v24 row_ror:2 row_mask:0xf bank_mask:0xf
    s_nop 1
    v_add_f32_dpp v24, v25, v25 row_ror:1 row_mask:0xf bank_mask:0xf
    s_nop 1
    v_readlane_b32 s70, v24, 0
    v_readlane_b32 s71, v24, 16
    v_readlane_b32 s72, v24, 32
    v_readlane_b32 s73, v24, 48
    s_nop 1
    v_mov_b32 v24, s70
    v_add_f32 v24, s71, v24
    v_add_f32 v24, s72, v24
    v_add_f32 v24, s73, v24
    v_mul_f32 v24, 0x3b000000, v24
    v_sub_f32 v16, v8, v24
    v_sub_f32 v17, v9, v24
    v_sub_f32 v18, v10, v24
    v_sub_f32 v19, v11, v24
    v_sub_f32 v20, v12, v24
    v_sub_f32 v21, v13, v24
    v_sub_f32 v22, v14, v24
    v_sub_f32 v23, v15, v24
    v_mul_f32 v26, v16, v16
    v_fmac_f32 v26, v17, v17
    v_fmac_f32 v26, v18, v18
    v_fmac_f32 v26, v19, v19
    v_fmac_f32 v26, v20, v20
    v_fmac_f32 v26, v21, v21
    v_fmac_f32 v26, v22, v22
    v_fmac_f32 v26, v23, v23
    s_nop 1
    v_add_f32_dpp v25, v26, v26 row_ror:8 row_mask:0xf bank_mask:0xf
    s_nop 1
    v_add_f32_dpp v26, v25, v25 row_ror:4 row_mask:0xf bank_mask:0xf
    s_nop 1
    v_add_f32_dpp v25, v26, v26 row_ror:2 row_mask:0xf bank_mask:0xf
    s_nop 1
    v_add_f32_dpp v26, v25, v25 row_ror:1 row_mask:0xf bank_mask:0xf
    s_nop 1
    v_readlane_b32 s70, v26, 0
    v_readlane_b32 s71, v26, 16
    v_readlane_b32 s72, v26, 32
    v_readlane_b32 s73, v26, 48
    s_nop 1
    v_mov_b32 v26, s70
    v_add_f32 v26, s71, v26
    v_add_f32 v26, s72, v26
    v_add_f32 v26, s73, v26
    v_mul_f32 v26, 0x3b000000, v26
    v_cvt_pk_bf16_f32 v24, v24, v24
    v_lshlrev_b32 v24, 16, v24
    v_cvt_pk_bf16_f32 v26, v26, v26
    v_lshlrev_b32 v26, 16, v26
    v_add_f32 v26, 0x3727c5ac, v26
    v_cvt_pk_bf16_f32 v26, v26, v26
    v_lshlrev_b32 v26, 16, v26
    v_sqrt_f32 v26, v26
    s_nop 0
    v_cvt_pk_bf16_f32 v26, v26, v26
    v_lshlrev_b32 v26, 16, v26
    v_rcp_f32 v26, v26
    s_nop 0
    v_sub_f32 v16, v8, v24
    v_sub_f32 v17, v9, v24
    v_sub_f32 v18, v10, v24
    v_sub_f32 v19, v11, v24
    v_sub_f32 v20, v12, v24
    v_sub_f32 v21, v13, v24
    v_sub_f32 v22, v14, v24
    v_sub_f32 v23, v15, v24
    v_cvt_pk_bf16_f32 v8, v16, v17
    v_cvt_pk_bf16_f32 v9, v18, v19
    v_cvt_pk_bf16_f32 v10, v20, v21
    v_cvt_pk_bf16_f32 v11, v22, v23
    v_lshlrev_b32 v16, 16, v8
    v_and_b32 v17, 0xffff0000, v8
    v_lshlrev_b32 v18, 16, v9
    v_and_b32 v19, 0xffff0000, v9
    v_lshlrev_b32 v20, 16, v10
    v_and_b32 v21, 0xffff0000, v10
    v_lshlrev_b32 v22, 16, v11
    v_and_b32 v23, 0xffff0000, v11
    v_mul_f32 v16, v16, v26
    v_mul_f32 v17, v17, v26
    v_mul_f32 v18, v18, v26
    v_mul_f32 v19, v19, v26
    v_mul_f32 v20, v20, v26
    v_mul_f32 v21, v21, v26
    v_mul_f32 v22, v22, v26
    v_mul_f32 v23, v23, v26
    v_cvt_pk_bf16_f32 v28, v16, v17
    v_cvt_pk_bf16_f32 v29, v18, v19
    v_cvt_pk_bf16_f32 v30, v20, v21
    v_cvt_pk_bf16_f32 v31, v22, v23
    buffer_store_dwordx4 v[28:31], v3, s[12:15], s28 offen
    s_branch ln0_kernel_end
ln0_kernel_tr:
    s_sub_u32 s27, s2, 512
    s_lshl_b32 s27, s27, 2
    s_add_u32 s27, s27, s26
    s_waitcnt lgkmcnt(0)
    s_cmp_ge_u32 s27, 224
    s_cbranch_scc1 ln0_kernel_tr2
    s_mov_b32 s4, s48
    s_mov_b32 s5, s49
    s_mov_b32 s6, 1835008
    s_mov_b32 s7, 0x00020000
    s_mov_b32 s8, s60
    s_mov_b32 s9, s61
    s_mov_b32 s10, 1835008
    s_mov_b32 s11, 0x00020000
    s_mul_i32 s28, s27, 9363
    s_lshr_b32 s28, s28, 18
    s_mul_i32 s29, s28, 28
    s_sub_u32 s29, s27, s29
    s_mov_b32 s30, 3584
    s_mov_b32 s31, 1024
    s_branch ln0_kernel_tr3
ln0_kernel_tr2:
    s_mov_b32 s4, s52
    s_mov_b32 s5, s53
    s_mov_b32 s6, 1835008
    s_mov_b32 s7, 0x00020000
    s_add_u32 s8, s60, 2097152
    s_addc_u32 s9, s61, 0
    s_mov_b32 s10, 1835008
    s_mov_b32 s11, 0x00020000
    s_sub_u32 s27, s27, 224
    s_lshr_b32 s28, s27, 3
    s_and_b32 s29, s27, 7
    s_mov_b32 s30, 1024
    s_mov_b32 s31, 3584
ln0_kernel_tr3:
    v_lshrrev_b32 v32, 3, v1
    v_and_b32 v33, 7, v1
    s_lshl_b32 s28, s28, 6
    s_lshl_b32 s29, s29, 6
    v_lshlrev_b32 v32, 3, v32
    v_add_u32 v32, s28, v32
    v_lshlrev_b32 v33, 3, v33
    v_add_u32 v33, s29, v33
    v_mul_lo_u32 v34, v32, s30
    v_lshlrev_b32 v2, 1, v33
    v_add_u32 v34, v34, v2
    v_mul_lo_u32 v35, v33, s31
    v_lshlrev_b32 v2, 1, v32
    v_add_u32 v35, v35, v2
    s_mov_b32 s32, 0
    buffer_load_dwordx4 v[36:39], v34, s[4:7], s32 offen
    s_add_u32 s32, s32, s30
    buffer_load_dwordx4 v[40:43], v34, s[4:7], s32 offen
    s_add_u32 s32, s32, s30
    buffer_load_dwordx4 v[44:47], v34, s[4:7], s32 offen
    s_add_u32 s32, s32, s30
    buffer_load_dwordx4 v[48:51], v34, s[4:7], s32 offen
    s_add_u32 s32, s32, s30
    buffer_load_dwordx4 v[52:55], v34, s[4:7], s32 offen
    s_add_u32 s32, s32, s30
    buffer_load_dwordx4 v[56:59], v34, s[4:7], s32 offen
    s_add_u32 s32, s32, s30
    buffer_load_dwordx4 v[60:63], v34, s[4:7], s32 offen
    s_add_u32 s32, s32, s30
    buffer_load_dwordx4 v[64:67], v34, s[4:7], s32 offen
    s_mov_b32 s33, 0x05040100
    s_mov_b32 s34, 0x07060302
    s_waitcnt vmcnt(0)
    v_perm_b32 v68, v40, v36, s33
    v_perm_b32 v69, v48, v44, s33
    v_perm_b32 v70, v56, v52, s33
    v_perm_b32 v71, v64, v60, s33
    v_perm_b32 v72, v40, v36, s34
    v_perm_b32 v73, v48, v44, s34
    v_perm_b32 v74, v56, v52, s34
    v_perm_b32 v75, v64, v60, s34
    v_perm_b32 v76, v41, v37, s33
    v_perm_b32 v77, v49, v45, s33
    v_perm_b32 v78, v57, v53, s33
    v_perm_b32 v79, v65, v61, s33
    v_perm_b32 v80, v41, v37, s34
    v_perm_b32 v81, v49, v45, s34
    v_perm_b32 v82, v57, v53, s34
    v_perm_b32 v83, v65, v61, s34
    v_perm_b32 v84, v42, v38, s33
    v_perm_b32 v85, v50, v46, s33
    v_perm_b32 v86, v58, v54, s33
    v_perm_b32 v87, v66, v62, s33
    v_perm_b32 v88, v42, v38, s34
    v_perm_b32 v89, v50, v46, s34
    v_perm_b32 v90, v58, v54, s34
    v_perm_b32 v91, v66, v62, s34
    v_perm_b32 v92, v43, v39, s33
    v_perm_b32 v93, v51, v47, s33
    v_perm_b32 v94, v59, v55, s33
    v_perm_b32 v95, v67, v63, s33
    v_perm_b32 v96, v43, v39, s34
    v_perm_b32 v97, v51, v47, s34
    v_perm_b32 v98, v59, v55, s34
    v_perm_b32 v99, v67, v63, s34
    s_mov_b32 s32, 0
    buffer_store_dwordx4 v[68:71], v35, s[8:11], s32 offen
    s_add_u32 s32, s32, s31
    buffer_store_dwordx4 v[72:75], v35, s[8:11], s32 offen
    s_add_u32 s32, s32, s31
    buffer_store_dwordx4 v[76:79], v35, s[8:11], s32 offen
    s_add_u32 s32, s32, s31
    buffer_store_dwordx4 v[80:83], v35, s[8:11], s32 offen
    s_add_u32 s32, s32, s31
    buffer_store_dwordx4 v[84:87], v35, s[8:11], s32 offen
    s_add_u32 s32, s32, s31
    buffer_store_dwordx4 v[88:91], v35, s[8:11], s32 offen
    s_add_u32 s32, s32, s31
    buffer_store_dwordx4 v[92:95], v35, s[8:11], s32 offen
    s_add_u32 s32, s32, s31
    buffer_store_dwordx4 v[96:99], v35, s[8:11], s32 offen
ln0_kernel_end:
    s_endpgm
.globl comb_kernel
.p2align 8
.type comb_kernel,@function
comb_kernel:
    s_cmp_ge_u32 s2, 512
    s_cbranch_scc1 comb_kernel_end
    s_load_dwordx16 s[36:51], s[0:1], 0
    s_load_dwordx8 s[52:59], s[0:1], 64
    s_load_dwordx2 s[60:61], s[0:1], 96
    v_and_b32 v1, 63, v0
    v_lshrrev_b32 v2, 6, v0
    s_nop 0
    v_readfirstlane_b32 s26, v2
    s_nop 1
    s_lshl_b32 s27, s2, 2
    s_add_u32 s27, s27, s26
    s_lshl_b32 s28, s27, 10
    v_lshlrev_b32 v3, 4, v1
    s_waitcnt lgkmcnt(0)
    s_mov_b32 s4, s56
    s_mov_b32 s5, s57
    s_mov_b32 s6, 2097152
    s_mov_b32 s7, 0x00020000
    s_mov_b32 s8, s56
    s_mov_b32 s9, s57
    s_mov_b32 s10, 2097152
    s_mov_b32 s11, 0x00020000
    s_add_u32 s12, s60, 4194304
    s_addc_u32 s13, s61, 0
    s_mov_b32 s14, 2097152
    s_mov_b32 s15, 0x00020000
    buffer_load_dwordx4 v[4:7], v3, s[4:7], s28 offen
    s_add_u32 s16, s60, 10485760
    s_addc_u32 s17, s61, 0
    s_mov_b32 s18, 2097152
    s_mov_b32 s19, 0x00020000
    s_add_u32 s20, s60, 12582912
    s_addc_u32 s21, s61, 0
    s_mov_b32 s22, 2097152
    s_mov_b32 s23, 0x00020000
    buffer_load_dwordx4 v[8:11], v3, s[16:19], s28 offen
    buffer_load_dwordx4 v[12:15], v3, s[20:23], s28 offen
    s_waitcnt vmcnt(0)
    v_lshlrev_b32 v16, 16, v8
    v_and_b32 v17, 0xffff0000, v8
    v_lshlrev_b32 v32, 16, v12
    v_and_b32 v33, 0xffff0000, v12
    v_lshlrev_b32 v18, 16, v9
    v_and_b32 v19, 0xffff0000, v9
    v_lshlrev_b32 v34, 16, v13
    v_and_b32 v35, 0xffff0000, v13
    v_lshlrev_b32 v20, 16, v10
    v_and_b32 v21, 0xffff0000, v10
    v_lshlrev_b32 v36, 16, v14
    v_and_b32 v37, 0xffff0000, v14
    v_lshlrev_b32 v22, 16, v11
    v_and_b32 v23, 0xffff0000, v11
    v_lshlrev_b32 v38, 16, v15
    v_and_b32 v39, 0xffff0000, v15
    v_sub_f32 v16, v16, v32
    v_sub_f32 v17, v17, v33
    v_sub_f32 v18, v18, v34
    v_sub_f32 v19, v19, v35
    v_sub_f32 v20, v20, v36
    v_sub_f32 v21, v21, v37
    v_sub_f32 v22, v22, v38
    v_sub_f32 v23, v23, v39
    v_cvt_pk_bf16_f32 v8, v16, v17
    v_cvt_pk_bf16_f32 v9, v18, v19
    v_cvt_pk_bf16_f32 v10, v20, v21
    v_cvt_pk_bf16_f32 v11, v22, v23
    v_lshlrev_b32 v16, 16, v8
    v_and_b32 v17, 0xffff0000, v8
    v_lshlrev_b32 v32, 16, v4
    v_and_b32 v33, 0xffff0000, v4
    v_lshlrev_b32 v18, 16, v9
    v_and_b32 v19, 0xffff0000, v9
    v_lshlrev_b32 v34, 16, v5
    v_and_b32 v35, 0xffff0000, v5
    v_lshlrev_b32 v20, 16, v10
    v_and_b32 v21, 0xffff0000, v10
    v_lshlrev_b32 v36, 16, v6
    v_and_b32 v37, 0xffff0000, v6
    v_lshlrev_b32 v22, 16, v11
    v_and_b32 v23, 0xffff0000, v11
    v_lshlrev_b32 v38, 16, v7
    v_and_b32 v39, 0xffff0000, v7
    v_add_f32 v16, v16, v32
    v_add_f32 v17, v17, v33
    v_add_f32 v18, v18, v34
    v_add_f32 v19, v19, v35
    v_add_f32 v20, v20, v36
    v_add_f32 v21, v21, v37
    v_add_f32 v22, v22, v38
    v_add_f32 v23, v23, v39
    v_cvt_pk_bf16_f32 v4, v16, v17
    v_cvt_pk_bf16_f32 v5, v18, v19
    v_cvt_pk_bf16_f32 v6, v20, v21
    v_cvt_pk_bf16_f32 v7, v22, v23
    buffer_store_dwordx4 v[4:7], v3, s[8:11], s28 offen
    v_lshlrev_b32 v16, 16, v4
    v_and_b32 v17, 0xffff0000, v4
    v_lshlrev_b32 v18, 16, v5
    v_and_b32 v19, 0xffff0000, v5
    v_lshlrev_b32 v20, 16, v6
    v_and_b32 v21, 0xffff0000, v6
    v_lshlrev_b32 v22, 16, v7
    v_and_b32 v23, 0xffff0000, v7
    v_add_f32 v40, v16, v17
    v_add_f32 v40, v40, v18
    v_add_f32 v40, v40, v19
    v_add_f32 v40, v40, v20
    v_add_f32 v40, v40, v21
    v_add_f32 v40, v40, v22
    v_add_f32 v40, v40, v23
    s_nop 1
    v_add_f32_dpp v41, v40, v40 row_ror:8 row_mask:0xf bank_mask:0xf
    s_nop 1
    v_add_f32_dpp v40, v41, v41 row_ror:4 row_mask:0xf bank_mask:0xf
    s_nop 1
    v_add_f32_dpp v41, v40, v40 row_ror:2 row_mask:0xf bank_mask:0xf
    s_nop 1
    v_add_f32_dpp v40, v41, v41 row_ror:1 row_mask:0xf bank_mask:0xf
    s_nop 1
    v_readlane_b32 s70, v40, 0
    v_readlane_b32 s71, v40, 16
    v_readlane_b32 s72, v40, 32
    v_readlane_b32 s73, v40, 48
    s_nop 1
    v_mov_b32 v40, s70
    v_add_f32 v40, s71, v40
    v_add_f32 v40, s72, v40
    v_add_f32 v40, s73, v40
    v_mul_f32 v40, 0x3b000000, v40
    v_sub_f32 v24, v16, v40
    v_sub_f32 v25, v17, v40
    v_sub_f32 v26, v18, v40
    v_sub_f32 v27, v19, v40
    v_sub_f32 v28, v20, v40
    v_sub_f32 v29, v21, v40
    v_sub_f32 v30, v22, v40
    v_sub_f32 v31, v23, v40
    v_mul_f32 v42, v24, v24
    v_fmac_f32 v42, v25, v25
    v_fmac_f32 v42, v26, v26
    v_fmac_f32 v42, v27, v27
    v_fmac_f32 v42, v28, v28
    v_fmac_f32 v42, v29, v29
    v_fmac_f32 v42, v30, v30
    v_fmac_f32 v42, v31, v31
    s_nop 1
    v_add_f32_dpp v41, v42, v42 row_ror:8 row_mask:0xf bank_mask:0xf
    s_nop 1
    v_add_f32_dpp v42, v41, v41 row_ror:4 row_mask:0xf bank_mask:0xf
    s_nop 1
    v_add_f32_dpp v41, v42, v42 row_ror:2 row_mask:0xf bank_mask:0xf
    s_nop 1
    v_add_f32_dpp v42, v41, v41 row_ror:1 row_mask:0xf bank_mask:0xf
    s_nop 1
    v_readlane_b32 s70, v42, 0
    v_readlane_b32 s71, v42, 16
    v_readlane_b32 s72, v42, 32
    v_readlane_b32 s73, v42, 48
    s_nop 1
    v_mov_b32 v42, s70
    v_add_f32 v42, s71, v42
    v_add_f32 v42, s72, v42
    v_add_f32 v42, s73, v42
    v_mul_f32 v42, 0x3b000000, v42
    v_cvt_pk_bf16_f32 v40, v40, v40
    v_lshlrev_b32 v40, 16, v40
    v_cvt_pk_bf16_f32 v42, v42, v42
    v_lshlrev_b32 v42, 16, v42
    v_add_f32 v42, 0x3727c5ac, v42
    v_cvt_pk_bf16_f32 v42, v42, v42
    v_lshlrev_b32 v42, 16, v42
    v_sqrt_f32 v42, v42
    s_nop 0
    v_cvt_pk_bf16_f32 v42, v42, v42
    v_lshlrev_b32 v42, 16, v42
    v_rcp_f32 v42, v42
    s_nop 0
    v_sub_f32 v24, v16, v40
    v_sub_f32 v25, v17, v40
    v_sub_f32 v26, v18, v40
    v_sub_f32 v27, v19, v40
    v_sub_f32 v28, v20, v40
    v_sub_f32 v29, v21, v40
    v_sub_f32 v30, v22, v40
    v_sub_f32 v31, v23, v40
    v_cvt_pk_bf16_f32 v16, v24, v25
    v_cvt_pk_bf16_f32 v17, v26, v27
    v_cvt_pk_bf16_f32 v18, v28, v29
    v_cvt_pk_bf16_f32 v19, v30, v31
    v_lshlrev_b32 v24, 16, v16
    v_and_b32 v25, 0xffff0000, v16
    v_lshlrev_b32 v26, 16, v17
    v_and_b32 v27, 0xffff0000, v17
    v_lshlrev_b32 v28, 16, v18
    v_and_b32 v29, 0xffff0000, v18
    v_lshlrev_b32 v30, 16, v19
    v_and_b32 v31, 0xffff0000, v19
    v_mul_f32 v24, v24, v42
    v_mul_f32 v25, v25, v42
    v_mul_f32 v26, v26, v42
    v_mul_f32 v27, v27, v42
    v_mul_f32 v28, v28, v42
    v_mul_f32 v29, v29, v42
    v_mul_f32 v30, v30, v42
    v_mul_f32 v31, v31, v42
    v_cvt_pk_bf16_f32 v44, v24, v25
    v_cvt_pk_bf16_f32 v45, v26, v27
    v_cvt_pk_bf16_f32 v46, v28, v29
    v_cvt_pk_bf16_f32 v47, v30, v31
    buffer_store_dwordx4 v[44:47], v3, s[12:15], s28 offen
    s_branch comb_kernel_end
comb_kernel_end:
    s_endpgm
.globl ln_kernel
.p2align 8
.type ln_kernel,@function
ln_kernel:
    s_cmp_ge_u32 s2, 512
    s_cbranch_scc1 ln_kernel_end
    s_load_dwordx16 s[36:51], s[0:1], 0
    s_load_dwordx8 s[52:59], s[0:1], 64
    s_load_dwordx2 s[60:61], s[0:1], 96
    v_and_b32 v1, 63, v0
    v_lshrrev_b32 v2, 6, v0
    s_nop 0
    v_readfirstlane_b32 s26, v2
    s_nop 1
    s_lshl_b32 s27, s2, 2
    s_add_u32 s27, s27, s26
    s_lshl_b32 s28, s27, 10
    v_lshlrev_b32 v3, 4, v1
    s_waitcnt lgkmcnt(0)
    s_mov_b32 s4, s56
    s_mov_b32 s5, s57
    s_mov_b32 s6, 2097152
    s_mov_b32 s7, 0x00020000
    s_mov_b32 s8, s56
    s_mov_b32 s9, s57
    s_mov_b32 s10, 2097152
    s_mov_b32 s11, 0x00020000
    s_add_u32 s12, s60, 4194304
    s_addc_u32 s13, s61, 0
    s_mov_b32 s14, 2097152
    s_mov_b32 s15, 0x00020000
    buffer_load_dwordx4 v[4:7], v3, s[4:7], s28 offen
    s_waitcnt vmcnt(0)
    v_lshlrev_b32 v8, 16, v4
    v_and_b32 v9, 0xffff0000, v4
    v_lshlrev_b32 v10, 16, v5
    v_and_b32 v11, 0xffff0000, v5
    v_lshlrev_b32 v12, 16, v6
    v_and_b32 v13, 0xffff0000, v6
    v_lshlrev_b32 v14, 16, v7
    v_and_b32 v15, 0xffff0000, v7
    v_add_f32 v24, v8, v9
    v_add_f32 v24, v24, v10
    v_add_f32 v24, v24, v11
    v_add_f32 v24, v24, v12
    v_add_f32 v24, v24, v13
    v_add_f32 v24, v24, v14
    v_add_f32 v24, v24, v15
    s_nop 1
    v_add_f32_dpp v25, v24, v24 row_ror:8 row_mask:0xf bank_mask:0xf
    s_nop 1
    v_add_f32_dpp v24, v25, v25 row_ror:4 row_mask:0xf bank_mask:0xf
    s_nop 1
    v_add_f32_dpp v25, v24, v24 row_ror:2 row_mask:0xf bank_mask:0xf
    s_nop 1
    v_add_f32_dpp v24, v25, v25 row_ror:1 row_mask:0xf bank_mask:0xf
    s_nop 1
    v_readlane_b32 s70, v24, 0
    v_readlane_b32 s71, v24, 16
    v_readlane_b32 s72, v24, 32
    v_readlane_b32 s73, v24, 48
    s_nop 1
    v_mov_b32 v24, s70
    v_add_f32 v24, s71, v24
    v_add_f32 v24, s72, v24
    v_add_f32 v24, s73, v24
    v_mul_f32 v24, 0x3b000000, v24
    v_sub_f32 v16, v8, v24
    v_sub_f32 v17, v9, v24
    v_sub_f32 v18, v10, v24
    v_sub_f32 v19, v11, v24
    v_sub_f32 v20, v12, v24
    v_sub_f32 v21, v13, v24
    v_sub_f32 v22, v14, v24
    v_sub_f32 v23, v15, v24
    v_mul_f32 v26, v16, v16
    v_fmac_f32 v26, v17, v17
    v_fmac_f32 v26, v18, v18
    v_fmac_f32 v26, v19, v19
    v_fmac_f32 v26, v20, v20
    v_fmac_f32 v26, v21, v21
    v_fmac_f32 v26, v22, v22
    v_fmac_f32 v26, v23, v23
    s_nop 1
    v_add_f32_dpp v25, v26, v26 row_ror:8 row_mask:0xf bank_mask:0xf
    s_nop 1
    v_add_f32_dpp v26, v25, v25 row_ror:4 row_mask:0xf bank_mask:0xf
    s_nop 1
    v_add_f32_dpp v25, v26, v26 row_ror:2 row_mask:0xf bank_mask:0xf
    s_nop 1
    v_add_f32_dpp v26, v25, v25 row_ror:1 row_mask:0xf bank_mask:0xf
    s_nop 1
    v_readlane_b32 s70, v26, 0
    v_readlane_b32 s71, v26, 16
    v_readlane_b32 s72, v26, 32
    v_readlane_b32 s73, v26, 48
    s_nop 1
    v_mov_b32 v26, s70
    v_add_f32 v26, s71, v26
    v_add_f32 v26, s72, v26
    v_add_f32 v26, s73, v26
    v_mul_f32 v26, 0x3b000000, v26
    v_cvt_pk_bf16_f32 v24, v24, v24
    v_lshlrev_b32 v24, 16, v24
    v_cvt_pk_bf16_f32 v26, v26, v26
    v_lshlrev_b32 v26, 16, v26
    v_add_f32 v26, 0x3727c5ac, v26
    v_cvt_pk_bf16_f32 v26, v26, v26
    v_lshlrev_b32 v26, 16, v26
    v_sqrt_f32 v26, v26
    s_nop 0
    v_cvt_pk_bf16_f32 v26, v26, v26
    v_lshlrev_b32 v26, 16, v26
    v_rcp_f32 v26, v26
    s_nop 0
    v_sub_f32 v16, v8, v24
    v_sub_f32 v17, v9, v24
    v_sub_f32 v18, v10, v24
    v_sub_f32 v19, v11, v24
    v_sub_f32 v20, v12, v24
    v_sub_f32 v21, v13, v24
    v_sub_f32 v22, v14, v24
    v_sub_f32 v23, v15, v24
    v_cvt_pk_bf16_f32 v8, v16, v17
    v_cvt_pk_bf16_f32 v9, v18, v19
    v_cvt_pk_bf16_f32 v10, v20, v21
    v_cvt_pk_bf16_f32 v11, v22, v23
    v_lshlrev_b32 v16, 16, v8
    v_and_b32 v17, 0xffff0000, v8
    v_lshlrev_b32 v18, 16, v9
    v_and_b32 v19, 0xffff0000, v9
    v_lshlrev_b32 v20, 16, v10
    v_and_b32 v21, 0xffff0000, v10
    v_lshlrev_b32 v22, 16, v11
    v_and_b32 v23, 0xffff0000, v11
    v_mul_f32 v16, v16, v26
    v_mul_f32 v17, v17, v26
    v_mul_f32 v18, v18, v26
    v_mul_f32 v19, v19, v26
    v_mul_f32 v20, v20, v26
    v_mul_f32 v21, v21, v26
    v_mul_f32 v22, v22, v26
    v_mul_f32 v23, v23, v26
    v_cvt_pk_bf16_f32 v28, v16, v17
    v_cvt_pk_bf16_f32 v29, v18, v19
    v_cvt_pk_bf16_f32 v30, v20, v21
    v_cvt_pk_bf16_f32 v31, v22, v23
    buffer_store_dwordx4 v[28:31], v3, s[12:15], s28 offen
    s_branch ln_kernel_end
ln_kernel_end:
    s_endpgm
.globl p1_kernel
.p2align 8
.type p1_kernel,@function
p1_kernel:
    s_cmp_ge_u32 s2, 256
    s_cbranch_scc1 p1_kernel_end
    s_load_dwordx16 s[36:51], s[0:1], 0
    s_load_dwordx8 s[52:59], s[0:1], 64
    s_load_dwordx2 s[60:61], s[0:1], 96
    v_and_b32 v1, 63, v0
    v_lshrrev_b32 v2, 6, v0
    s_nop 0
    v_readfirstlane_b32 s26, v2
    s_nop 1
    s_lshl_b32 s27, s26, 10
    s_mov_b32 s62, 0
    s_mov_b32 s63, s26
    s_waitcnt lgkmcnt(0)
    s_and_b32 s30, s2, 7
    s_lshr_b32 s31, s2, 3
    s_lshl_b32 s30, s30, 2
    s_and_b32 s32, s31, 3
    s_add_u32 s30, s30, s32
    s_lshl_b32 s28, s30, 6
    s_lshr_b32 s31, s31, 2
    s_lshl_b32 s29, s31, 7
    s_add_u32 s4, s60, 4194304
    s_addc_u32 s5, s61, 0
    s_mov_b32 s6, 2097152
    s_mov_b32 s7, 0x00020000
    s_cmp_ge_u32 s29, 512
    s_cselect_b32 s8, s44, s42
    s_cselect_b32 s9, s45, s43
    s_mov_b32 s10, 524288
    s_mov_b32 s11, 0x00020000
    s_and_b32 s64, s29, 511
    s_add_u32 s12, s60, 6291456
    s_addc_u32 s13, s61, 0
    s_mov_b32 s14, 4194304
    s_mov_b32 s15, 0x00020000
    s_mul_i32 s24, s28, 1024
    s_mul_i32 s25, s64, 1024
    v_lshrrev_b32 v2, 4, v1
    s_and_b32 s30, s26, 1
    s_lshl_b32 s30, s30, 2
    v_add_u32 v2, s30, v2
    v_and_b32 v3, 7, v1
    v_xor_b32 v2, v2, v3
    v_lshlrev_b32 v2, 4, v2
    v_lshrrev_b32 v3, 3, v1
    s_lshl_b32 s30, s26, 3
    v_add_u32 v3, s30, v3
    s_mov_b32 s31, 1024
    s_mov_b32 s32, 1024
    v_add_u32 v4, 0, v3
    v_mul_lo_u32 v5, v4, s31
    v_add_u32 v5, v5, v2
    v_add_u32 v4, 32, v3
    v_mul_lo_u32 v6, v4, s31
    v_add_u32 v6, v6, v2
    v_add_u32 v4, 0, v3
    v_mul_lo_u32 v7, v4, s32
    v_add_u32 v7, v7, v2
    v_add_u32 v4, 32, v3
    v_mul_lo_u32 v8, v4, s32
    v_add_u32 v8, v8, v2
    v_add_u32 v4, 64, v3
    v_mul_lo_u32 v9, v4, s32
    v_add_u32 v9, v9, v2
    v_add_u32 v4, 96, v3
    v_mul_lo_u32 v10, v4, s32
    v_add_u32 v10, v10, v2
    v_and_b32 v2, 31, v1
    v_lshrrev_b32 v3, 1, v2
    v_and_b32 v3, 7, v3
    v_lshrrev_b32 v4, 5, v1
    v_xor_b32 v3, v3, v4
    v_lshlrev_b32 v3, 4, v3
    v_lshlrev_b32 v2, 7, v2
    v_add_u32 v2, v2, v3
    s_mul_i32 s30, s62, 8192
    s_mul_i32 s31, s63, 4096
    s_add_u32 s31, s31, 8192
    v_xor_b32 v3, 0, v2
    v_add_u32 v11, s30, v3
    v_add_u32 v19, s31, v3
    v_add_u32 v15, 65536, v11
    v_add_u32 v23, 65536, v19
    v_xor_b32 v3, 32, v2
    v_add_u32 v12, s30, v3
    v_add_u32 v20, s31, v3
    v_add_u32 v16, 65536, v12
    v_add_u32 v24, 65536, v20
    v_xor_b32 v3, 64, v2
    v_add_u32 v13, s30, v3
    v_add_u32 v21, s31, v3
    v_add_u32 v17, 65536, v13
    v_add_u32 v25, 65536, v21
    v_xor_b32 v3, 96, v2
    v_add_u32 v14, s30, v3
    v_add_u32 v22, s31, v3
    v_add_u32 v18, 65536, v14
    v_add_u32 v26, 65536, v22
    s_mov_b32 m0, s27
    s_nop 0
    buffer_load_dwordx4 v5, s[4:7], s24 offen lds
    s_add_u32 m0, s27, 4096
    s_nop 0
    buffer_load_dwordx4 v6, s[4:7], s24 offen lds
    s_add_u32 m0, s27, 8192
    s_nop 0
    buffer_load_dwordx4 v7, s[8:11], s25 offen lds
    s_add_u32 m0, s27, 12288
    s_nop 0
    buffer_load_dwordx4 v8, s[8:11], s25 offen lds
    s_add_u32 m0, s27, 16384
    s_nop 0
    buffer_load_dwordx4 v9, s[8:11], s25 offen lds
    s_add_u32 m0, s27, 20480
    s_nop 0
    buffer_load_dwordx4 v10, s[8:11], s25 offen lds
    s_add_u32 s24, s24, 128
    s_add_u32 s25, s25, 128
    s_add_u32 m0, s27, 24576
    s_nop 0
    buffer_load_dwordx4 v5, s[4:7], s24 offen lds
    s_add_u32 m0, s27, 28672
    s_nop 0
    buffer_load_dwordx4 v6, s[4:7], s24 offen lds
    s_add_u32 m0, s27, 32768
    s_nop 0
    buffer_load_dwordx4 v7, s[8:11], s25 offen lds
    s_add_u32 m0, s27, 36864
    s_nop 0
    buffer_load_dwordx4 v8, s[8:11], s25 offen lds
    s_add_u32 m0, s27, 40960
    s_nop 0
    buffer_load_dwordx4 v9, s[8:11], s25 offen lds
    s_add_u32 m0, s27, 45056
    s_nop 0
    buffer_load_dwordx4 v10, s[8:11], s25 offen lds
    s_add_u32 s24, s24, 128
    s_add_u32 s25, s25, 128
    s_add_u32 m0, s27, 49152
    s_nop 0
    buffer_load_dwordx4 v5, s[4:7], s24 offen lds
    s_add_u32 m0, s27, 53248
    s_nop 0
    buffer_load_dwordx4 v6, s[4:7], s24 offen lds
    s_add_u32 m0, s27, 57344
    s_nop 0
    buffer_load_dwordx4 v7, s[8:11], s25 offen lds
    s_add_u32 m0, s27, 61440
    s_nop 0
    buffer_load_dwordx4 v8, s[8:11], s25 offen lds
    s_add_u32 m0, s27, 65536
    s_nop 0
    buffer_load_dwordx4 v9, s[8:11], s25 offen lds
    s_add_u32 m0, s27, 69632
    s_nop 0
    buffer_load_dwordx4 v10, s[8:11], s25 offen lds
    s_add_u32 s24, s24, 128
    s_add_u32 s25, s25, 128
    s_add_u32 m0, s27, 73728
    s_nop 0
    buffer_load_dwordx4 v5, s[4:7], s24 offen lds
    s_add_u32 m0, s27, 77824
    s_nop 0
    buffer_load_dwordx4 v6, s[4:7], s24 offen lds
    s_add_u32 m0, s27, 81920
    s_nop 0
    buffer_load_dwordx4 v7, s[8:11], s25 offen lds
    s_add_u32 m0, s27, 86016
    s_nop 0
    buffer_load_dwordx4 v8, s[8:11], s25 offen lds
    s_add_u32 m0, s27, 90112
    s_nop 0
    buffer_load_dwordx4 v9, s[8:11], s25 offen lds
    s_add_u32 m0, s27, 94208
    s_nop 0
    buffer_load_dwordx4 v10, s[8:11], s25 offen lds
    s_add_u32 s24, s24, 128
    s_add_u32 s25, s25, 128
    s_waitcnt vmcnt(18)
    s_barrier
    ds_read_b128 v[28:31], v11 offset:0
    ds_read_b128 v[32:35], v11 offset:4096
    ds_read_b128 v[44:47], v19 offset:0
    ds_read_b128 v[36:39], v12 offset:0
    ds_read_b128 v[40:43], v12 offset:4096
    ds_read_b128 v[48:51], v20 offset:0
    s_waitcnt lgkmcnt(3)
    v_mfma_f32_32x32x16_bf16 v[52:67], v[28:31], v[44:47], 0
    v_mfma_f32_32x32x16_bf16 v[68:83], v[32:35], v[44:47], 0
    ds_read_b128 v[28:31], v13 offset:0
    ds_read_b128 v[32:35], v13 offset:4096
    ds_read_b128 v[44:47], v21 offset:0
    s_waitcnt lgkmcnt(3)
    v_mfma_f32_32x32x16_bf16 v[52:67], v[36:39], v[48:51], v[52:67]
    v_mfma_f32_32x32x16_bf16 v[68:83], v[40:43], v[48:51], v[68:83]
    ds_read_b128 v[36:39], v14 offset:0
    ds_read_b128 v[40:43], v14 offset:4096
    ds_read_b128 v[48:51], v22 offset:0
    s_waitcnt lgkmcnt(3)
    v_mfma_f32_32x32x16_bf16 v[52:67], v[28:31], v[44:47], v[52:67]
    v_mfma_f32_32x32x16_bf16 v[68:83], v[32:35], v[44:47], v[68:83]
    s_waitcnt vmcnt(12)
    s_barrier
    ds_read_b128 v[28:31], v11 offset:24576
    ds_read_b128 v[32:35], v11 offset:28672
    ds_read_b128 v[44:47], v19 offset:24576
    s_waitcnt lgkmcnt(3)
    s_add_u32 m0, s27, 98304
    v_mfma_f32_32x32x16_bf16 v[52:67], v[36:39], v[48:51], v[52:67]
    buffer_load_dwordx4 v5, s[4:7], s24 offen lds
    s_add_u32 m0, s27, 102400
    s_nop 0
    buffer_load_dwordx4 v6, s[4:7], s24 offen lds
    s_add_u32 m0, s27, 106496
    s_nop 0
    buffer_load_dwordx4 v7, s[8:11], s25 offen lds
    s_add_u32 m0, s27, 110592
    v_mfma_f32_32x32x16_bf16 v[68:83], v[40:43], v[48:51], v[68:83]
    buffer_load_dwordx4 v8, s[8:11], s25 offen lds
    s_add_u32 m0, s27, 114688
    s_nop 0
    buffer_load_dwordx4 v9, s[8:11], s25 offen lds
    s_add_u32 m0, s27, 118784
    s_nop 0
    buffer_load_dwordx4 v10, s[8:11], s25 offen lds
    s_add_u32 s24, s24, 128
    s_add_u32 s25, s25, 128
    ds_read_b128 v[36:39], v12 offset:24576
    ds_read_b128 v[40:43], v12 offset:28672
    ds_read_b128 v[48:51], v20 offset:24576
    s_waitcnt lgkmcnt(3)
    v_mfma_f32_32x32x16_bf16 v[52:67], v[28:31], v[44:47], v[52:67]
    v_mfma_f32_32x32x16_bf16 v[68:83], v[32:35], v[44:47], v[68:83]
    ds_read_b128 v[28:31], v13 offset:24576
    ds_read_b128 v[32:35], v13 offset:28672
    ds_read_b128 v[44:47], v21 offset:24576
    s_waitcnt lgkmcnt(3)
    v_mfma_f32_32x32x16_bf16 v[52:67], v[36:39], v[48:51], v[52:67]
    v_mfma_f32_32x32x16_bf16 v[68:83], v[40:43], v[48:51], v[68:83]
    ds_read_b128 v[36:39], v14 offset:24576
    ds_read_b128 v[40:43], v14 offset:28672
    ds_read_b128 v[48:51], v22 offset:24576
    s_waitcnt lgkmcnt(3)
    v_mfma_f32_32x32x16_bf16 v[52:67], v[28:31], v[44:47], v[52:67]
    v_mfma_f32_32x32x16_bf16 v[68:83], v[32:35], v[44:47], v[68:83]
    s_waitcnt vmcnt(12)
    s_barrier
    ds_read_b128 v[28:31], v11 offset:49152
    ds_read_b128 v[32:35], v11 offset:53248
    ds_read_b128 v[44:47], v19 offset:49152
    s_waitcnt lgkmcnt(3)
    s_mov_b32 m0, s27
    v_mfma_f32_32x32x16_bf16 v[52:67], v[36:39], v[48:51], v[52:67]
    buffer_load_dwordx4 v5, s[4:7], s24 offen lds
    s_add_u32 m0, s27, 4096
    s_nop 0
    buffer_load_dwordx4 v6, s[4:7], s24 offen lds
    s_add_u32 m0, s27, 8192
    s_nop 0
    buffer_load_dwordx4 v7, s[8:11], s25 offen lds
    s_add_u32 m0, s27, 12288
    v_mfma_f32_32x32x16_bf16 v[68:83], v[40:43], v[48:51], v[68:83]
    buffer_load_dwordx4 v8, s[8:11], s25 offen lds
    s_add_u32 m0, s27, 16384
    s_nop 0
    buffer_load_dwordx4 v9, s[8:11], s25 offen lds
    s_add_u32 m0, s27, 20480
    s_nop 0
    buffer_load_dwordx4 v10, s[8:11], s25 offen lds
    s_add_u32 s24, s24, 128
    s_add_u32 s25, s25, 128
    ds_read_b128 v[36:39], v12 offset:49152
    ds_read_b128 v[40:43], v12 offset:53248
    ds_read_b128 v[48:51], v20 offset:49152
    s_waitcnt lgkmcnt(3)
    v_mfma_f32_32x32x16_bf16 v[52:67], v[28:31], v[44:47], v[52:67]
    v_mfma_f32_32x32x16_bf16 v[68:83], v[32:35], v[44:47], v[68:83]
    ds_read_b128 v[28:31], v13 offset:49152
    ds_read_b128 v[32:35], v13 offset:53248
    ds_read_b128 v[44:47], v21 offset:49152
    s_waitcnt lgkmcnt(3)
    v_mfma_f32_32x32x16_bf16 v[52:67], v[36:39], v[48:51], v[52:67]
    v_mfma_f32_32x32x16_bf16 v[68:83], v[40:43], v[48:51], v[68:83]
    ds_read_b128 v[36:39], v14 offset:49152
    ds_read_b128 v[40:43], v14 offset:53248
    ds_read_b128 v[48:51], v22 offset:49152
    s_waitcnt lgkmcnt(3)
    v_mfma_f32_32x32x16_bf16 v[52:67], v[28:31], v[44:47], v[52:67]
    v_mfma_f32_32x32x16_bf16 v[68:83], v[32:35], v[44:47], v[68:83]
    s_waitcnt vmcnt(12)
    s_barrier
    ds_read_b128 v[28:31], v15 offset:8192
    ds_read_b128 v[32:35], v15 offset:12288
    ds_read_b128 v[44:47], v23 offset:8192
    s_waitcnt lgkmcnt(3)
    s_add_u32 m0, s27, 24576
    v_mfma_f32_32x32x16_bf16 v[52:67], v[36:39], v[48:51], v[52:67]
    buffer_load_dwordx4 v5, s[4:7], s24 offen lds
    s_add_u32 m0, s27, 28672
    s_nop 0
    buffer_load_dwordx4 v6, s[4:7], s24 offen lds
    s_add_u32 m0, s27, 32768
    s_nop 0
    buffer_load_dwordx4 v7, s[8:11], s25 offen lds
    s_add_u32 m0, s27, 36864
    v_mfma_f32_32x32x16_bf16 v[68:83], v[40:43], v[48:51], v[68:83]
    buffer_load_dwordx4 v8, s[8:11], s25 offen lds
    s_add_u32 m0, s27, 40960
    s_nop 0
    buffer_load_dwordx4 v9, s[8:11], s25 offen lds
    s_add_u32 m0, s27, 45056
    s_nop 0
    buffer_load_dwordx4 v10, s[8:11], s25 offen lds
    s_add_u32 s24, s24, 128
    s_add_u32 s25, s25, 128
    ds_read_b128 v[36:39], v16 offset:8192
    ds_read_b128 v[40:43], v16 offset:12288
    ds_read_b128 v[48:51], v24 offset:8192
    s_waitcnt lgkmcnt(3)
    v_mfma_f32_32x32x16_bf16 v[52:67], v[28:31], v[44:47], v[52:67]
    v_mfma_f32_32x32x16_bf16 v[68:83], v[32:35], v[44:47], v[68:83]
    ds_read_b128 v[28:31], v17 offset:8192
    ds_read_b128 v[32:35], v17 offset:12288
    ds_read_b128 v[44:47], v25 offset:8192
    s_waitcnt lgkmcnt(3)
    v_mfma_f32_32x32x16_bf16 v[52:67], v[36:39], v[48:51], v[52:67]
    v_mfma_f32_32x32x16_bf16 v[68:83], v[40:43], v[48:51], v[68:83]
    ds_read_b128 v[36:39], v18 offset:8192
    ds_read_b128 v[40:43], v18 offset:12288
    ds_read_b128 v[48:51], v26 offset:8192
    s_waitcnt lgkmcnt(3)
    v_mfma_f32_32x32x16_bf16 v[52:67], v[28:31], v[44:47], v[52:67]
    v_mfma_f32_32x32x16_bf16 v[68:83], v[32:35], v[44:47], v[68:83]
    s_waitcnt vmcnt(12)
    s_barrier
    ds_read_b128 v[28:31], v15 offset:32768
    ds_read_b128 v[32:35], v15 offset:36864
    ds_read_b128 v[44:47], v23 offset:32768
    s_waitcnt lgkmcnt(3)
    s_add_u32 m0, s27, 49152
    v_mfma_f32_32x32x16_bf16 v[52:67], v[36:39], v[48:51], v[52:67]
    buffer_load_dwordx4 v5, s[4:7], s24 offen lds
    s_add_u32 m0, s27, 53248
    s_nop 0
    buffer_load_dwordx4 v6, s[4:7], s24 offen lds
    s_add_u32 m0, s27, 57344
    s_nop 0
    buffer_load_dwordx4 v7, s[8:11], s25 offen lds
    s_add_u32 m0, s27, 61440
    v_mfma_f32_32x32x16_bf16 v[68:83], v[40:43], v[48:51], v[68:83]
    buffer_load_dwordx4 v8, s[8:11], s25 offen lds
    s_add_u32 m0, s27, 65536
    s_nop 0
    buffer_load_dwordx4 v9, s[8:11], s25 offen lds
    s_add_u32 m0, s27, 69632
    s_nop 0
    buffer_load_dwordx4 v10, s[8:11], s25 offen lds
    s_add_u32 s24, s24, 128
    s_add_u32 s25, s25, 128
    ds_read_b128 v[36:39], v16 offset:32768
    ds_read_b128 v[40:43], v16 offset:36864
    ds_read_b128 v[48:51], v24 offset:32768
    s_waitcnt lgkmcnt(3)
    v_mfma_f32_32x32x16_bf16 v[52:67], v[28:31], v[44:47], v[52:67]
    v_mfma_f32_32x32x16_bf16 v[68:83], v[32:35], v[44:47], v[68:83]
    ds_read_b128 v[28:31], v17 offset:32768
    ds_read_b128 v[32:35], v17 offset:36864
    ds_read_b128 v[44:47], v25 offset:32768
    s_waitcnt lgkmcnt(3)
    v_mfma_f32_32x32x16_bf16 v[52:67], v[36:39], v[48:51], v[52:67]
    v_mfma_f32_32x32x16_bf16 v[68:83], v[40:43], v[48:51], v[68:83]
    ds_read_b128 v[36:39], v18 offset:32768
    ds_read_b128 v[40:43], v18 offset:36864
    ds_read_b128 v[48:51], v26 offset:32768
    s_waitcnt lgkmcnt(3)
    v_mfma_f32_32x32x16_bf16 v[52:67], v[28:31], v[44:47], v[52:67]
    v_mfma_f32_32x32x16_bf16 v[68:83], v[32:35], v[44:47], v[68:83]
    s_waitcnt vmcnt(12)
    s_barrier
    ds_read_b128 v[28:31], v11 offset:0
    ds_read_b128 v[32:35], v11 offset:4096
    ds_read_b128 v[44:47], v19 offset:0
    s_waitcnt lgkmcnt(3)
    v_mfma_f32_32x32x16_bf16 v[52:67], v[36:39], v[48:51], v[52:67]
    v_mfma_f32_32x32x16_bf16 v[68:83], v[40:43], v[48:51], v[68:83]
    ds_read_b128 v[36:39], v12 offset:0
    ds_read_b128 v[40:43], v12 offset:4096
    ds_read_b128 v[48:51], v20 offset:0
    s_waitcnt lgkmcnt(3)
    v_mfma_f32_32x32x16_bf16 v[52:67], v[28:31], v[44:47], v[52:67]
    v_mfma_f32_32x32x16_bf16 v[68:83], v[32:35], v[44:47], v[68:83]
    ds_read_b128 v[28:31], v13 offset:0
    ds_read_b128 v[32:35], v13 offset:4096
    ds_read_b128 v[44:47], v21 offset:0
    s_waitcnt lgkmcnt(3)
    v_mfma_f32_32x32x16_bf16 v[52:67], v[36:39], v[48:51], v[52:67]
    v_mfma_f32_32x32x16_bf16 v[68:83], v[40:43], v[48:51], v[68:83]
    ds_read_b128 v[36:39], v14 offset:0
    ds_read_b128 v[40:43], v14 offset:4096
    ds_read_b128 v[48:51], v22 offset:0
    s_waitcnt lgkmcnt(3)
    v_mfma_f32_32x32x16_bf16 v[52:67], v[28:31], v[44:47], v[52:67]
    v_mfma_f32_32x32x16_bf16 v[68:83], v[32:35], v[44:47], v[68:83]
    s_waitcnt vmcnt(6)
    s_barrier
    ds_read_b128 v[28:31], v11 offset:24576
    ds_read_b128 v[32:35], v11 offset:28672
    ds_read_b128 v[44:47], v19 offset:24576
    s_waitcnt lgkmcnt(3)
    v_mfma_f32_32x32x16_bf16 v[52:67], v[36:39], v[48:51], v[52:67]
    v_mfma_f32_32x32x16_bf16 v[68:83], v[40:43], v[48:51], v[68:83]
    ds_read_b128 v[36:39], v12 offset:24576
    ds_read_b128 v[40:43], v12 offset:28672
    ds_read_b128 v[48:51], v20 offset:24576
    s_waitcnt lgkmcnt(3)
    v_mfma_f32_32x32x16_bf16 v[52:67], v[28:31], v[44:47], v[52:67]
    v_mfma_f32_32x32x16_bf16 v[68:83], v[32:35], v[44:47], v[68:83]
    ds_read_b128 v[28:31], v13 offset:24576
    ds_read_b128 v[32:35], v13 offset:28672
    ds_read_b128 v[44:47], v21 offset:24576
    s_waitcnt lgkmcnt(3)
    v_mfma_f32_32x32x16_bf16 v[52:67], v[36:39], v[48:51], v[52:67]
    v_mfma_f32_32x32x16_bf16 v[68:83], v[40:43], v[48:51], v[68:83]
    ds_read_b128 v[36:39], v14 offset:24576
    ds_read_b128 v[40:43], v14 offset:28672
    ds_read_b128 v[48:51], v22 offset:24576
    s_waitcnt lgkmcnt(3)
    v_mfma_f32_32x32x16_bf16 v[52:67], v[28:31], v[44:47], v[52:67]
    v_mfma_f32_32x32x16_bf16 v[68:83], v[32:35], v[44:47], v[68:83]
    s_waitcnt vmcnt(0)
    s_barrier
    ds_read_b128 v[28:31], v11 offset:49152
    ds_read_b128 v[32:35], v11 offset:53248
    ds_read_b128 v[44:47], v19 offset:49152
    s_waitcnt lgkmcnt(3)
    v_mfma_f32_32x32x16_bf16 v[52:67], v[36:39], v[48:51], v[52:67]
    v_mfma_f32_32x32x16_bf16 v[68:83], v[40:43], v[48:51], v[68:83]
    ds_read_b128 v[36:39], v12 offset:49152
    ds_read_b128 v[40:43], v12 offset:53248
    ds_read_b128 v[48:51], v20 offset:49152
    s_waitcnt lgkmcnt(3)
    v_mfma_f32_32x32x16_bf16 v[52:67], v[28:31], v[44:47], v[52:67]
    v_mfma_f32_32x32x16_bf16 v[68:83], v[32:35], v[44:47], v[68:83]
    ds_read_b128 v[28:31], v13 offset:49152
    ds_read_b128 v[32:35], v13 offset:53248
    ds_read_b128 v[44:47], v21 offset:49152
    s_waitcnt lgkmcnt(3)
    v_mfma_f32_32x32x16_bf16 v[52:67], v[36:39], v[48:51], v[52:67]
    v_mfma_f32_32x32x16_bf16 v[68:83], v[40:43], v[48:51], v[68:83]
    ds_read_b128 v[36:39], v14 offset:49152
    ds_read_b128 v[40:43], v14 offset:53248
    ds_read_b128 v[48:51], v22 offset:49152
    s_waitcnt lgkmcnt(3)
    v_mfma_f32_32x32x16_bf16 v[52:67], v[28:31], v[44:47], v[52:67]
    v_mfma_f32_32x32x16_bf16 v[68:83], v[32:35], v[44:47], v[68:83]
    s_waitcnt lgkmcnt(0)
    v_mfma_f32_32x32x16_bf16 v[52:67], v[36:39], v[48:51], v[52:67]
    v_mfma_f32_32x32x16_bf16 v[68:83], v[40:43], v[48:51], v[68:83]
    s_nop 15
    v_and_b32 v84, 31, v1
    s_mul_i32 s30, s63, 32
    v_add_u32 v84, s30, v84
    s_mov_b32 s30, 4096
    v_mul_lo_u32 v84, v84, s30
    v_lshrrev_b32 v86, 5, v1
    v_lshlrev_b32 v86, 3, v86
    v_add_u32 v85, v84, v86
    v_add_u32 v84, v85, v86
    s_mul_i32 s33, s29, 4096
    s_mul_i32 s30, s62, 64
    s_add_u32 s30, s30, s28
    s_lshl_b32 s30, s30, 1
    s_add_u32 s33, s33, s30
    s_add_u32 s34, s33, 0
    v_cvt_pk_bf16_f32 v88, v52, v53
    v_cvt_pk_bf16_f32 v89, v54, v55
    v_cvt_pk_bf16_f32 v90, v56, v57
    v_cvt_pk_bf16_f32 v91, v58, v59
    s_nop 1
    v_permlane32_swap_b32 v88, v90
    v_permlane32_swap_b32 v89, v91
    buffer_store_dwordx4 v[88:91], v84, s[12:15], s34 offen offset:0
    v_cvt_pk_bf16_f32 v92, v60, v61
    v_cvt_pk_bf16_f32 v93, v62, v63
    v_cvt_pk_bf16_f32 v94, v64, v65
    v_cvt_pk_bf16_f32 v95, v66, v67
    s_nop 1
    v_permlane32_swap_b32 v92, v94
    v_permlane32_swap_b32 v93, v95
    buffer_store_dwordx4 v[92:95], v84, s[12:15], s34 offen offset:32
    v_cvt_pk_bf16_f32 v88, v68, v69
    v_cvt_pk_bf16_f32 v89, v70, v71
    v_cvt_pk_bf16_f32 v90, v72, v73
    v_cvt_pk_bf16_f32 v91, v74, v75
    s_nop 1
    v_permlane32_swap_b32 v88, v90
    v_permlane32_swap_b32 v89, v91
    buffer_store_dwordx4 v[88:91], v84, s[12:15], s34 offen offset:64
    v_cvt_pk_bf16_f32 v92, v76, v77
    v_cvt_pk_bf16_f32 v93, v78, v79
    v_cvt_pk_bf16_f32 v94, v80, v81
    v_cvt_pk_bf16_f32 v95, v82, v83
    s_nop 1
    v_permlane32_swap_b32 v92, v94
    v_permlane32_swap_b32 v93, v95
    buffer_store_dwordx4 v[92:95], v84, s[12:15], s34 offen offset:96
p1_kernel_end:
    s_endpgm
.globl p2_kernel
.p2align 8
.type p2_kernel,@function
p2_kernel:
    s_cmp_ge_u32 s2, 256
    s_cbranch_scc1 p2_kernel_end
    s_load_dwordx16 s[36:51], s[0:1], 0
    s_load_dwordx8 s[52:59], s[0:1], 64
    s_load_dwordx2 s[60:61], s[0:1], 96
    v_and_b32 v1, 63, v0
    v_lshrrev_b32 v2, 6, v0
    s_nop 0
    v_readfirstlane_b32 s26, v2
    s_nop 1
    s_lshl_b32 s27, s26, 10
    s_mov_b32 s62, 0
    s_mov_b32 s63, s26
    s_waitcnt lgkmcnt(0)
    s_and_b32 s30, s2, 7
    s_lshr_b32 s31, s2, 3
    s_and_b32 s64, s30, 1
    s_lshr_b32 s30, s30, 1
    s_lshl_b32 s30, s30, 2
    s_and_b32 s32, s31, 3
    s_add_u32 s30, s30, s32
    s_lshl_b32 s29, s30, 7
    s_lshr_b32 s31, s31, 2
    s_lshl_b32 s28, s31, 6
    s_mul_i32 s30, s64, 2097152
    s_add_u32 s4, s60, 6291456
    s_addc_u32 s5, s61, 0
    s_add_u32 s4, s4, s30
    s_addc_u32 s5, s5, 0
    s_mov_b32 s6, 2097152
    s_mov_b32 s7, 0x00020000
    s_cmp_eq_u32 s64, 1
    s_cselect_b32 s8, s40, s38
    s_cselect_b32 s9, s41, s39
    s_mov_b32 s10, 8388608
    s_mov_b32 s11, 0x00020000
    s_mul_i32 s30, s64, 2097152
    s_add_u32 s12, s60, 10485760
    s_addc_u32 s13, s61, 0
    s_add_u32 s12, s12, s30
    s_addc_u32 s13, s13, 0
    s_mov_b32 s14, 2097152
    s_mov_b32 s15, 0x00020000
    s_mul_i32 s24, s28, 4096
    s_mul_i32 s25, s29, 4096
    v_lshrrev_b32 v2, 4, v1
    s_and_b32 s30, s26, 1
    s_lshl_b32 s30, s30, 2
    v_add_u32 v2, s30, v2
    v_and_b32 v3, 7, v1
    v_xor_b32 v2, v2, v3
    v_lshlrev_b32 v2, 4, v2
    v_lshrrev_b32 v3, 3, v1
    s_lshl_b32 s30, s26, 3
    v_add_u32 v3, s30, v3
    s_mov_b32 s31, 4096
    s_mov_b32 s32, 4096
    v_add_u32 v4, 0, v3
    v_mul_lo_u32 v5, v4, s31
    v_add_u32 v5, v5, v2
    v_add_u32 v4, 32, v3
    v_mul_lo_u32 v6, v4, s31
    v_add_u32 v6, v6, v2
    v_add_u32 v4, 0, v3
    v_mul_lo_u32 v7, v4, s32
    v_add_u32 v7, v7, v2
    v_add_u32 v4, 32, v3
    v_mul_lo_u32 v8, v4, s32
    v_add_u32 v8, v8, v2
    v_add_u32 v4, 64, v3
    v_mul_lo_u32 v9, v4, s32
    v_add_u32 v9, v9, v2
    v_add_u32 v4, 96, v3
    v_mul_lo_u32 v10, v4, s32
    v_add_u32 v10, v10, v2
    v_and_b32 v2, 31, v1
    v_lshrrev_b32 v3, 1, v2
    v_and_b32 v3, 7, v3
    v_lshrrev_b32 v4, 5, v1
    v_xor_b32 v3, v3, v4
    v_lshlrev_b32 v3, 4, v3
    v_lshlrev_b32 v2, 7, v2
    v_add_u32 v2, v2, v3
    s_mul_i32 s30, s62, 8192
    s_mul_i32 s31, s63, 4096
    s_add_u32 s31, s31, 8192
    v_xor_b32 v3, 0, v2
    v_add_u32 v11, s30, v3
    v_add_u32 v19, s31, v3
    v_add_u32 v15, 65536, v11
    v_add_u32 v23, 65536, v19
    v_xor_b32 v3, 32, v2
    v_add_u32 v12, s30, v3
    v_add_u32 v20, s31, v3
    v_add_u32 v16, 65536, v12
    v_add_u32 v24, 65536, v20
    v_xor_b32 v3, 64, v2
    v_add_u32 v13, s30, v3
    v_add_u32 v21, s31, v3
    v_add_u32 v17, 65536, v13
    v_add_u32 v25, 65536, v21
    v_xor_b32 v3, 96, v2
    v_add_u32 v14, s30, v3
    v_add_u32 v22, s31, v3
    v_add_u32 v18, 65536, v14
    v_add_u32 v26, 65536, v22
    s_mov_b32 m0, s27
    s_nop 0
    buffer_load_dwordx4 v5, s[4:7], s24 offen lds
    s_add_u32 m0, s27, 4096
    s_nop 0
    buffer_load_dwordx4 v6, s[4:7], s24 offen lds
    s_add_u32 m0, s27, 8192
    s_nop 0
    buffer_load_dwordx4 v7, s[8:11], s25 offen lds
    s_add_u32 m0, s27, 12288
    s_nop 0
    buffer_load_dwordx4 v8, s[8:11], s25 offen lds
    s_add_u32 m0, s27, 16384
    s_nop 0
    buffer_load_dwordx4 v9, s[8:11], s25 offen lds
    s_add_u32 m0, s27, 20480
    s_nop 0
    buffer_load_dwordx4 v10, s[8:11], s25 offen lds
    s_add_u32 s24, s24, 128
    s_add_u32 s25, s25, 128
    s_add_u32 m0, s27, 24576
    s_nop 0
    buffer_load_dwordx4 v5, s[4:7], s24 offen lds
    s_add_u32 m0, s27, 28672
    s_nop 0
    buffer_load_dwordx4 v6, s[4:7], s24 offen lds
    s_add_u32 m0, s27, 32768
    s_nop 0
    buffer_load_dwordx4 v7, s[8:11], s25 offen lds
    s_add_u32 m0, s27, 36864
    s_nop 0
    buffer_load_dwordx4 v8, s[8:11], s25 offen lds
    s_add_u32 m0, s27, 40960
    s_nop 0
    buffer_load_dwordx4 v9, s[8:11], s25 offen lds
    s_add_u32 m0, s27, 45056
    s_nop 0
    buffer_load_dwordx4 v10, s[8:11], s25 offen lds
    s_add_u32 s24, s24, 128
    s_add_u32 s25, s25, 128
    s_add_u32 m0, s27, 49152
    s_nop 0
    buffer_load_dwordx4 v5, s[4:7], s24 offen lds
    s_add_u32 m0, s27, 53248
    s_nop 0
    buffer_load_dwordx4 v6, s[4:7], s24 offen lds
    s_add_u32 m0, s27, 57344
    s_nop 0
    buffer_load_dwordx4 v7, s[8:11], s25 offen lds
    s_add_u32 m0, s27, 61440
    s_nop 0
    buffer_load_dwordx4 v8, s[8:11], s25 offen lds
    s_add_u32 m0, s27, 65536
    s_nop 0
    buffer_load_dwordx4 v9, s[8:11], s25 offen lds
    s_add_u32 m0, s27, 69632
    s_nop 0
    buffer_load_dwordx4 v10, s[8:11], s25 offen lds
    s_add_u32 s24, s24, 128
    s_add_u32 s25, s25, 128
    s_add_u32 m0, s27, 73728
    s_nop 0
    buffer_load_dwordx4 v5, s[4:7], s24 offen lds
    s_add_u32 m0, s27, 77824
    s_nop 0
    buffer_load_dwordx4 v6, s[4:7], s24 offen lds
    s_add_u32 m0, s27, 81920
    s_nop 0
    buffer_load_dwordx4 v7, s[8:11], s25 offen lds
    s_add_u32 m0, s27, 86016
    s_nop 0
    buffer_load_dwordx4 v8, s[8:11], s25 offen lds
    s_add_u32 m0, s27, 90112
    s_nop 0
    buffer_load_dwordx4 v9, s[8:11], s25 offen lds
    s_add_u32 m0, s27, 94208
    s_nop 0
    buffer_load_dwordx4 v10, s[8:11], s25 offen lds
    s_add_u32 s24, s24, 128
    s_add_u32 s25, s25, 128
    s_waitcnt vmcnt(18)
    s_barrier
    ds_read_b128 v[28:31], v11 offset:0
    ds_read_b128 v[32:35], v11 offset:4096
    ds_read_b128 v[44:47], v19 offset:0
    ds_read_b128 v[36:39], v12 offset:0
    ds_read_b128 v[40:43], v12 offset:4096
    ds_read_b128 v[48:51], v20 offset:0
    s_waitcnt lgkmcnt(3)
    v_mfma_f32_32x32x16_bf16 v[52:67], v[28:31], v[44:47], 0
    v_mfma_f32_32x32x16_bf16 v[68:83], v[32:35], v[44:47], 0
    ds_read_b128 v[28:31], v13 offset:0
    ds_read_b128 v[32:35], v13 offset:4096
    ds_read_b128 v[44:47], v21 offset:0
    s_waitcnt lgkmcnt(3)
    v_mfma_f32_32x32x16_bf16 v[52:67], v[36:39], v[48:51], v[52:67]
    v_mfma_f32_32x32x16_bf16 v[68:83], v[40:43], v[48:51], v[68:83]
    ds_read_b128 v[36:39], v14 offset:0
    ds_read_b128 v[40:43], v14 offset:4096
    ds_read_b128 v[48:51], v22 offset:0
    s_waitcnt lgkmcnt(3)
    v_mfma_f32_32x32x16_bf16 v[52:67], v[28:31], v[44:47], v[52:67]
    v_mfma_f32_32x32x16_bf16 v[68:83], v[32:35], v[44:47], v[68:83]
    s_waitcnt vmcnt(12)
    s_barrier
    ds_read_b128 v[28:31], v11 offset:24576
    ds_read_b128 v[32:35], v11 offset:28672
    ds_read_b128 v[44:47], v19 offset:24576
    s_waitcnt lgkmcnt(3)
    s_add_u32 m0, s27, 98304
    v_mfma_f32_32x32x16_bf16 v[52:67], v[36:39], v[48:51], v[52:67]
    buffer_load_dwordx4 v5, s[4:7], s24 offen lds
    s_add_u32 m0, s27, 102400
    s_nop 0
    buffer_load_dwordx4 v6, s[4:7], s24 offen lds
    s_add_u32 m0, s27, 106496
    s_nop 0
    buffer_load_dwordx4 v7, s[8:11], s25 offen lds
    s_add_u32 m0, s27, 110592
    v_mfma_f32_32x32x16_bf16 v[68:83], v[40:43], v[48:51], v[68:83]
    buffer_load_dwordx4 v8, s[8:11], s25 offen lds
    s_add_u32 m0, s27, 114688
    s_nop 0
    buffer_load_dwordx4 v9, s[8:11], s25 offen lds
    s_add_u32 m0, s27, 118784
    s_nop 0
    buffer_load_dwordx4 v10, s[8:11], s25 offen lds
    s_add_u32 s24, s24, 128
    s_add_u32 s25, s25, 128
    ds_read_b128 v[36:39], v12 offset:24576
    ds_read_b128 v[40:43], v12 offset:28672
    ds_read_b128 v[48:51], v20 offset:24576
    s_waitcnt lgkmcnt(3)
    v_mfma_f32_32x32x16_bf16 v[52:67], v[28:31], v[44:47], v[52:67]
    v_mfma_f32_32x32x16_bf16 v[68:83], v[32:35], v[44:47], v[68:83]
    ds_read_b128 v[28:31], v13 offset:24576
    ds_read_b128 v[32:35], v13 offset:28672
    ds_read_b128 v[44:47], v21 offset:24576
    s_waitcnt lgkmcnt(3)
    v_mfma_f32_32x32x16_bf16 v[52:67], v[36:39], v[48:51], v[52:67]
    v_mfma_f32_32x32x16_bf16 v[68:83], v[40:43], v[48:51], v[68:83]
    ds_read_b128 v[36:39], v14 offset:24576
    ds_read_b128 v[40:43], v14 offset:28672
    ds_read_b128 v[48:51], v22 offset:24576
    s_waitcnt lgkmcnt(3)
    v_mfma_f32_32x32x16_bf16 v[52:67], v[28:31], v[44:47], v[52:67]
    v_mfma_f32_32x32x16_bf16 v[68:83], v[32:35], v[44:47], v[68:83]
    s_waitcnt vmcnt(12)
    s_barrier
    ds_read_b128 v[28:31], v11 offset:49152
    ds_read_b128 v[32:35], v11 offset:53248
    ds_read_b128 v[44:47], v19 offset:49152
    s_waitcnt lgkmcnt(3)
    s_mov_b32 m0, s27
    v_mfma_f32_32x32x16_bf16 v[52:67], v[36:39], v[48:51], v[52:67]
    buffer_load_dwordx4 v5, s[4:7], s24 offen lds
    s_add_u32 m0, s27, 4096
    s_nop 0
    buffer_load_dwordx4 v6, s[4:7], s24 offen lds
    s_add_u32 m0, s27, 8192
    s_nop 0
    buffer_load_dwordx4 v7, s[8:11], s25 offen lds
    s_add_u32 m0, s27, 12288
    v_mfma_f32_32x32x16_bf16 v[68:83], v[40:43], v[48:51], v[68:83]
    buffer_load_dwordx4 v8, s[8:11], s25 offen lds
    s_add_u32 m0, s27, 16384
    s_nop 0
    buffer_load_dwordx4 v9, s[8:11], s25 offen lds
    s_add_u32 m0, s27, 20480
    s_nop 0
    buffer_load_dwordx4 v10, s[8:11], s25 offen lds
    s_add_u32 s24, s24, 128
    s_add_u32 s25, s25, 128
    ds_read_b128 v[36:39], v12 offset:49152
    ds_read_b128 v[40:43], v12 offset:53248
    ds_read_b128 v[48:51], v20 offset:49152
    s_waitcnt lgkmcnt(3)
    v_mfma_f32_32x32x16_bf16 v[52:67], v[28:31], v[44:47], v[52:67]
    v_mfma_f32_32x32x16_bf16 v[68:83], v[32:35], v[44:47], v[68:83]
    ds_read_b128 v[28:31], v13 offset:49152
    ds_read_b128 v[32:35], v13 offset:53248
    ds_read_b128 v[44:47], v21 offset:49152
    s_waitcnt lgkmcnt(3)
    v_mfma_f32_32x32x16_bf16 v[52:67], v[36:39], v[48:51], v[52:67]
    v_mfma_f32_32x32x16_bf16 v[68:83], v[40:43], v[48:51], v[68:83]
    ds_read_b128 v[36:39], v14 offset:49152
    ds_read_b128 v[40:43], v14 offset:53248
    ds_read_b128 v[48:51], v22 offset:49152
    s_waitcnt lgkmcnt(3)
    v_mfma_f32_32x32x16_bf16 v[52:67], v[28:31], v[44:47], v[52:67]
    v_mfma_f32_32x32x16_bf16 v[68:83], v[32:35], v[44:47], v[68:83]
    s_waitcnt vmcnt(12)
    s_barrier
    ds_read_b128 v[28:31], v15 offset:8192
    ds_read_b128 v[32:35], v15 offset:12288
    ds_read_b128 v[44:47], v23 offset:8192
    s_waitcnt lgkmcnt(3)
    s_add_u32 m0, s27, 24576
    v_mfma_f32_32x32x16_bf16 v[52:67], v[36:39], v[48:51], v[52:67]
    buffer_load_dwordx4 v5, s[4:7], s24 offen lds
    s_add_u32 m0, s27, 28672
    s_nop 0
    buffer_load_dwordx4 v6, s[4:7], s24 offen lds
    s_add_u32 m0, s27, 32768
    s_nop 0
    buffer_load_dwordx4 v7, s[8:11], s25 offen lds
    s_add_u32 m0, s27, 36864
    v_mfma_f32_32x32x16_bf16 v[68:83], v[40:43], v[48:51], v[68:83]
    buffer_load_dwordx4 v8, s[8:11], s25 offen lds
    s_add_u32 m0, s27, 40960
    s_nop 0
    buffer_load_dwordx4 v9, s[8:11], s25 offen lds
    s_add_u32 m0, s27, 45056
    s_nop 0
    buffer_load_dwordx4 v10, s[8:11], s25 offen lds
    s_add_u32 s24, s24, 128
    s_add_u32 s25, s25, 128
    ds_read_b128 v[36:39], v16 offset:8192
    ds_read_b128 v[40:43], v16 offset:12288
    ds_read_b128 v[48:51], v24 offset:8192
    s_waitcnt lgkmcnt(3)
    v_mfma_f32_32x32x16_bf16 v[52:67], v[28:31], v[44:47], v[52:67]
    v_mfma_f32_32x32x16_bf16 v[68:83], v[32:35], v[44:47], v[68:83]
    ds_read_b128 v[28:31], v17 offset:8192
    ds_read_b128 v[32:35], v17 offset:12288
    ds_read_b128 v[44:47], v25 offset:8192
    s_waitcnt lgkmcnt(3)
    v_mfma_f32_32x32x16_bf16 v[52:67], v[36:39], v[48:51], v[52:67]
    v_mfma_f32_32x32x16_bf16 v[68:83], v[40:43], v[48:51], v[68:83]
    ds_read_b128 v[36:39], v18 offset:8192
    ds_read_b128 v[40:43], v18 offset:12288
    ds_read_b128 v[48:51], v26 offset:8192
    s_waitcnt lgkmcnt(3)
    v_mfma_f32_32x32x16_bf16 v[52:67], v[28:31], v[44:47], v[52:67]
    v_mfma_f32_32x32x16_bf16 v[68:83], v[32:35], v[44:47], v[68:83]
    s_waitcnt vmcnt(12)
    s_barrier
    ds_read_b128 v[28:31], v15 offset:32768
    ds_read_b128 v[32:35], v15 offset:36864
    ds_read_b128 v[44:47], v23 offset:32768
    s_waitcnt lgkmcnt(3)
    s_add_u32 m0, s27, 49152
    v_mfma_f32_32x32x16_bf16 v[52:67], v[36:39], v[48:51], v[52:67]
    buffer_load_dwordx4 v5, s[4:7], s24 offen lds
    s_add_u32 m0, s27, 53248
    s_nop 0
    buffer_load_dwordx4 v6, s[4:7], s24 offen lds
    s_add_u32 m0, s27, 57344
    s_nop 0
    buffer_load_dwordx4 v7, s[8:11], s25 offen lds
    s_add_u32 m0, s27, 61440
    v_mfma_f32_32x32x16_bf16 v[68:83], v[40:43], v[48:51], v[68:83]
    buffer_load_dwordx4 v8, s[8:11], s25 offen lds
    s_add_u32 m0, s27, 65536
    s_nop 0
    buffer_load_dwordx4 v9, s[8:11], s25 offen lds
    s_add_u32 m0, s27, 69632
    s_nop 0
    buffer_load_dwordx4 v10, s[8:11], s25 offen lds
    s_add_u32 s24, s24, 128
    s_add_u32 s25, s25, 128
    ds_read_b128 v[36:39], v16 offset:32768
    ds_read_b128 v[40:43], v16 offset:36864
    ds_read_b128 v[48:51], v24 offset:32768
    s_waitcnt lgkmcnt(3)
    v_mfma_f32_32x32x16_bf16 v[52:67], v[28:31], v[44:47], v[52:67]
    v_mfma_f32_32x32x16_bf16 v[68:83], v[32:35], v[44:47], v[68:83]
    ds_read_b128 v[28:31], v17 offset:32768
    ds_read_b128 v[32:35], v17 offset:36864
    ds_read_b128 v[44:47], v25 offset:32768
    s_waitcnt lgkmcnt(3)
    v_mfma_f32_32x32x16_bf16 v[52:67], v[36:39], v[48:51], v[52:67]
    v_mfma_f32_32x32x16_bf16 v[68:83], v[40:43], v[48:51], v[68:83]
    ds_read_b128 v[36:39], v18 offset:32768
    ds_read_b128 v[40:43], v18 offset:36864
    ds_read_b128 v[48:51], v26 offset:32768
    s_waitcnt lgkmcnt(3)
    v_mfma_f32_32x32x16_bf16 v[52:67], v[28:31], v[44:47], v[52:67]
    v_mfma_f32_32x32x16_bf16 v[68:83], v[32:35], v[44:47], v[68:83]
    s_waitcnt vmcnt(12)
    s_barrier
    ds_read_b128 v[28:31], v11 offset:0
    ds_read_b128 v[32:35], v11 offset:4096
    ds_read_b128 v[44:47], v19 offset:0
    s_waitcnt lgkmcnt(3)
    s_add_u32 m0, s27, 73728
    v_mfma_f32_32x32x16_bf16 v[52:67], v[36:39], v[48:51], v[52:67]
    buffer_load_dwordx4 v5, s[4:7], s24 offen lds
    s_add_u32 m0, s27, 77824
    s_nop 0
    buffer_load_dwordx4 v6, s[4:7], s24 offen lds
    s_add_u32 m0, s27, 81920
    s_nop 0
    buffer_load_dwordx4 v7, s[8:11], s25 offen lds
    s_add_u32 m0, s27, 86016
    v_mfma_f32_32x32x16_bf16 v[68:83], v[40:43], v[48:51], v[68:83]
    buffer_load_dwordx4 v8, s[8:11], s25 offen lds
    s_add_u32 m0, s27, 90112
    s_nop 0
    buffer_load_dwordx4 v9, s[8:11], s25 offen lds
    s_add_u32 m0, s27, 94208
    s_nop 0
    buffer_load_dwordx4 v10, s[8:11], s25 offen lds
    s_add_u32 s24, s24, 128
    s_add_u32 s25, s25, 128
    ds_read_b128 v[36:39], v12 offset:0
    ds_read_b128 v[40:43], v12 offset:4096
    ds_read_b128 v[48:51], v20 offset:0
    s_waitcnt lgkmcnt(3)
    v_mfma_f32_32x32x16_bf16 v[52:67], v[28:31], v[44:47], v[52:67]
    v_mfma_f32_32x32x16_bf16 v[68:83], v[32:35], v[44:47], v[68:83]
    ds_read_b128 v[28:31], v13 offset:0
    ds_read_b128 v[32:35], v13 offset:4096
    ds_read_b128 v[44:47], v21 offset:0
    s_waitcnt lgkmcnt(3)
    v_mfma_f32_32x32x16_bf16 v[52:67], v[36:39], v[48:51], v[52:67]
    v_mfma_f32_32x32x16_bf16 v[68:83], v[40:43], v[48:51], v[68:83]
    ds_read_b128 v[36:39], v14 offset:0
    ds_read_b128 v[40:43], v14 offset:4096
    ds_read_b128 v[48:51], v22 offset:0
    s_waitcnt lgkmcnt(3)
    v_mfma_f32_32x32x16_bf16 v[52:67], v[28:31], v[44:47], v[52:67]
    v_mfma_f32_32x32x16_bf16 v[68:83], v[32:35], v[44:47], v[68:83]
    s_waitcnt vmcnt(12)
    s_barrier
    ds_read_b128 v[28:31], v11 offset:24576
    ds_read_b128 v[32:35], v11 offset:28672
    ds_read_b128 v[44:47], v19 offset:24576
    s_waitcnt lgkmcnt(3)
    s_add_u32 m0, s27, 98304
    v_mfma_f32_32x32x16_bf16 v[52:67], v[36:39], v[48:51], v[52:67]
    buffer_load_dwordx4 v5, s[4:7], s24 offen lds
    s_add_u32 m0, s27, 102400
    s_nop 0
    buffer_load_dwordx4 v6, s[4:7], s24 offen lds
    s_add_u32 m0, s27, 106496
    s_nop 0
    buffer_load_dwordx4 v7, s[8:11], s25 offen lds
    s_add_u32 m0, s27, 110592
    v_mfma_f32_32x32x16_bf16 v[68:83], v[40:43], v[48:51], v[68:83]
    buffer_load_dwordx4 v8, s[8:11], s25 offen lds
    s_add_u32 m0, s27, 114688
    s_nop 0
    buffer_load_dwordx4 v9, s[8:11], s25 offen lds
    s_add_u32 m0, s27, 118784
    s_nop 0
    buffer_load_dwordx4 v10, s[8:11], s25 offen lds
    s_add_u32 s24, s24, 128
    s_add_u32 s25, s25, 128
    ds_read_b128 v[36:39], v12 offset:24576
    ds_read_b128 v[40:43], v12 offset:28672
    ds_read_b128 v[48:51], v20 offset:24576
    s_waitcnt lgkmcnt(3)
    v_mfma_f32_32x32x16_bf16 v[52:67], v[28:31], v[44:47], v[52:67]
    v_mfma_f32_32x32x16_bf16 v[68:83], v[32:35], v[44:47], v[68:83]
    ds_read_b128 v[28:31], v13 offset:24576
    ds_read_b128 v[32:35], v13 offset:28672
    ds_read_b128 v[44:47], v21 offset:24576
    s_waitcnt lgkmcnt(3)
    v_mfma_f32_32x32x16_bf16 v[52:67], v[36:39], v[48:51], v[52:67]
    v_mfma_f32_32x32x16_bf16 v[68:83], v[40:43], v[48:51], v[68:83]
    ds_read_b128 v[36:39], v14 offset:24576
    ds_read_b128 v[40:43], v14 offset:28672
    ds_read_b128 v[48:51], v22 offset:24576
    s_waitcnt lgkmcnt(3)
    v_mfma_f32_32x32x16_bf16 v[52:67], v[28:31], v[44:47], v[52:67]
    v_mfma_f32_32x32x16_bf16 v[68:83], v[32:35], v[44:47], v[68:83]
    s_waitcnt vmcnt(12)
    s_barrier
    ds_read_b128 v[28:31], v11 offset:49152
    ds_read_b128 v[32:35], v11 offset:53248
    ds_read_b128 v[44:47], v19 offset:49152
    s_waitcnt lgkmcnt(3)
    s_mov_b32 m0, s27
    v_mfma_f32_32x32x16_bf16 v[52:67], v[36:39], v[48:51], v[52:67]
    buffer_load_dwordx4 v5, s[4:7], s24 offen lds
    s_add_u32 m0, s27, 4096
    s_nop 0
    buffer_load_dwordx4 v6, s[4:7], s24 offen lds
    s_add_u32 m0, s27, 8192
    s_nop 0
    buffer_load_dwordx4 v7, s[8:11], s25 offen lds
    s_add_u32 m0, s27, 12288
    v_mfma_f32_32x32x16_bf16 v[68:83], v[40:43], v[48:51], v[68:83]
    buffer_load_dwordx4 v8, s[8:11], s25 offen lds
    s_add_u32 m0, s27, 16384
    s_nop 0
    buffer_load_dwordx4 v9, s[8:11], s25 offen lds
    s_add_u32 m0, s27, 20480
    s_nop 0
    buffer_load_dwordx4 v10, s[8:11], s25 offen lds
    s_add_u32 s24, s24, 128
    s_add_u32 s25, s25, 128
    ds_read_b128 v[36:39], v12 offset:49152
    ds_read_b128 v[40:43], v12 offset:53248
    ds_read_b128 v[48:51], v20 offset:49152
    s_waitcnt lgkmcnt(3)
    v_mfma_f32_32x32x16_bf16 v[52:67], v[28:31], v[44:47], v[52:67]
    v_mfma_f32_32x32x16_bf16 v[68:83], v[32:35], v[44:47], v[68:83]
    ds_read_b128 v[28:31], v13 offset:49152
    ds_read_b128 v[32:35], v13 offset:53248
    ds_read_b128 v[44:47], v21 offset:49152
    s_waitcnt lgkmcnt(3)
    v_mfma_f32_32x32x16_bf16 v[52:67], v[36:39], v[48:51], v[52:67]
    v_mfma_f32_32x32x16_bf16 v[68:83], v[40:43], v[48:51], v[68:83]
    ds_read_b128 v[36:39], v14 offset:49152
    ds_read_b128 v[40:43], v14 offset:53248
    ds_read_b128 v[48:51], v22 offset:49152
    s_waitcnt lgkmcnt(3)
    v_mfma_f32_32x32x16_bf16 v[52:67], v[28:31], v[44:47], v[52:67]
    v_mfma_f32_32x32x16_bf16 v[68:83], v[32:35], v[44:47], v[68:83]
    s_waitcnt vmcnt(12)
    s_barrier
    ds_read_b128 v[28:31], v15 offset:8192
    ds_read_b128 v[32:35], v15 offset:12288
    ds_read_b128 v[44:47], v23 offset:8192
    s_waitcnt lgkmcnt(3)
    s_add_u32 m0, s27, 24576
    v_mfma_f32_32x32x16_bf16 v[52:67], v[36:39], v[48:51], v[52:67]
    buffer_load_dwordx4 v5, s[4:7], s24 offen lds
    s_add_u32 m0, s27, 28672
    s_nop 0
    buffer_load_dwordx4 v6, s[4:7], s24 offen lds
    s_add_u32 m0, s27, 32768
    s_nop 0
    buffer_load_dwordx4 v7, s[8:11], s25 offen lds
    s_add_u32 m0, s27, 36864
    v_mfma_f32_32x32x16_bf16 v[68:83], v[40:43], v[48:51], v[68:83]
    buffer_load_dwordx4 v8, s[8:11], s25 offen lds
    s_add_u32 m0, s27, 40960
    s_nop 0
    buffer_load_dwordx4 v9, s[8:11], s25 offen lds
    s_add_u32 m0, s27, 45056
    s_nop 0
    buffer_load_dwordx4 v10, s[8:11], s25 offen lds
    s_add_u32 s24, s24, 128
    s_add_u32 s25, s25, 128
    ds_read_b128 v[36:39], v16 offset:8192
    ds_read_b128 v[40:43], v16 offset:12288
    ds_read_b128 v[48:51], v24 offset:8192
    s_waitcnt lgkmcnt(3)
    v_mfma_f32_32x32x16_bf16 v[52:67], v[28:31], v[44:47], v[52:67]
    v_mfma_f32_32x32x16_bf16 v[68:83], v[32:35], v[44:47], v[68:83]
    ds_read_b128 v[28:31], v17 offset:8192
    ds_read_b128 v[32:35], v17 offset:12288
    ds_read_b128 v[44:47], v25 offset:8192
    s_waitcnt lgkmcnt(3)
    v_mfma_f32_32x32x16_bf16 v[52:67], v[36:39], v[48:51], v[52:67]
    v_mfma_f32_32x32x16_bf16 v[68:83], v[40:43], v[48:51], v[68:83]
    ds_read_b128 v[36:39], v18 offset:8192
    ds_read_b128 v[40:43], v18 offset:12288
    ds_read_b128 v[48:51], v26 offset:8192
    s_waitcnt lgkmcnt(3)
    v_mfma_f32_32x32x16_bf16 v[52:67], v[28:31], v[44:47], v[52:67]
    v_mfma_f32_32x32x16_bf16 v[68:83], v[32:35], v[44:47], v[68:83]
    s_waitcnt vmcnt(12)
    s_barrier
    ds_read_b128 v[28:31], v15 offset:32768
    ds_read_b128 v[32:35], v15 offset:36864
    ds_read_b128 v[44:47], v23 offset:32768
    s_waitcnt lgkmcnt(3)
    s_add_u32 m0, s27, 49152
    v_mfma_f32_32x32x16_bf16 v[52:67], v[36:39], v[48:51], v[52:67]
    buffer_load_dwordx4 v5, s[4:7], s24 offen lds
    s_add_u32 m0, s27, 53248
    s_nop 0
    buffer_load_dwordx4 v6, s[4:7], s24 offen lds
    s_add_u32 m0, s27, 57344
    s_nop 0
    buffer_load_dwordx4 v7, s[8:11], s25 offen lds
    s_add_u32 m0, s27, 61440
    v_mfma_f32_32x32x16_bf16 v[68:83], v[40:43], v[48:51], v[68:83]
    buffer_load_dwordx4 v8, s[8:11], s25 offen lds
    s_add_u32 m0, s27, 65536
    s_nop 0
    buffer_load_dwordx4 v9, s[8:11], s25 offen lds
    s_add_u32 m0, s27, 69632
    s_nop 0
    buffer_load_dwordx4 v10, s[8:11], s25 offen lds
    s_add_u32 s24, s24, 128
    s_add_u32 s25, s25, 128
    ds_read_b128 v[36:39], v16 offset:32768
    ds_read_b128 v[40:43], v16 offset:36864
    ds_read_b128 v[48:51], v24 offset:32768
    s_waitcnt lgkmcnt(3)
    v_mfma_f32_32x32x16_bf16 v[52:67], v[28:31], v[44:47], v[52:67]
    v_mfma_f32_32x32x16_bf16 v[68:83], v[32:35], v[44:47], v[68:83]
    ds_read_b128 v[28:31], v17 offset:32768
    ds_read_b128 v[32:35], v17 offset:36864
    ds_read_b128 v[44:47], v25 offset:32768
    s_waitcnt lgkmcnt(3)
    v_mfma_f32_32x32x16_bf16 v[52:67], v[36:39], v[48:51], v[52:67]
    v_mfma_f32_32x32x16_bf16 v[68:83], v[40:43], v[48:51], v[68:83]
    ds_read_b128 v[36:39], v18 offset:32768
    ds_read_b128 v[40:43], v18 offset:36864
    ds_read_b128 v[48:51], v26 offset:32768
    s_waitcnt lgkmcnt(3)
    v_mfma_f32_32x32x16_bf16 v[52:67], v[28:31], v[44:47], v[52:67]
    v_mfma_f32_32x32x16_bf16 v[68:83], v[32:35], v[44:47], v[68:83]
    s_waitcnt vmcnt(12)
    s_barrier
    ds_read_b128 v[28:31], v11 offset:0
    ds_read_b128 v[32:35], v11 offset:4096
    ds_read_b128 v[44:47], v19 offset:0
    s_waitcnt lgkmcnt(3)
    s_add_u32 m0, s27, 73728
    v_mfma_f32_32x32x16_bf16 v[52:67], v[36:39], v[48:51], v[52:67]
    buffer_load_dwordx4 v5, s[4:7], s24 offen lds
    s_add_u32 m0, s27, 77824
    s_nop 0
    buffer_load_dwordx4 v6, s[4:7], s24 offen lds
    s_add_u32 m0, s27, 81920
    s_nop 0
    buffer_load_dwordx4 v7, s[8:11], s25 offen lds
    s_add_u32 m0, s27, 86016
    v_mfma_f32_32x32x16_bf16 v[68:83], v[40:43], v[48:51], v[68:83]
    buffer_load_dwordx4 v8, s[8:11], s25 offen lds
    s_add_u32 m0, s27, 90112
    s_nop 0
    buffer_load_dwordx4 v9, s[8:11], s25 offen lds
    s_add_u32 m0, s27, 94208
    s_nop 0
    buffer_load_dwordx4 v10, s[8:11], s25 offen lds
    s_add_u32 s24, s24, 128
    s_add_u32 s25, s25, 128
    ds_read_b128 v[36:39], v12 offset:0
    ds_read_b128 v[40:43], v12 offset:4096
    ds_read_b128 v[48:51], v20 offset:0
    s_waitcnt lgkmcnt(3)
    v_mfma_f32_32x32x16_bf16 v[52:67], v[28:31], v[44:47], v[52:67]
    v_mfma_f32_32x32x16_bf16 v[68:83], v[32:35], v[44:47], v[68:83]
    ds_read_b128 v[28:31], v13 offset:0
    ds_read_b128 v[32:35], v13 offset:4096
    ds_read_b128 v[44:47], v21 offset:0
    s_waitcnt lgkmcnt(3)
    v_mfma_f32_32x32x16_bf16 v[52:67], v[36:39], v[48:51], v[52:67]
    v_mfma_f32_32x32x16_bf16 v[68:83], v[40:43], v[48:51], v[68:83]
    ds_read_b128 v[36:39], v14 offset:0
    ds_read_b128 v[40:43], v14 offset:4096
    ds_read_b128 v[48:51], v22 offset:0
    s_waitcnt lgkmcnt(3)
    v_mfma_f32_32x32x16_bf16 v[52:67], v[28:31], v[44:47], v[52:67]
    v_mfma_f32_32x32x16_bf16 v[68:83], v[32:35], v[44:47], v[68:83]
    s_waitcnt vmcnt(12)
    s_barrier
    ds_read_b128 v[28:31], v11 offset:24576
    ds_read_b128 v[32:35], v11 offset:28672
    ds_read_b128 v[44:47], v19 offset:24576
    s_waitcnt lgkmcnt(3)
    s_add_u32 m0, s27, 98304
    v_mfma_f32_32x32x16_bf16 v[52:67], v[36:39], v[48:51], v[52:67]
    buffer_load_dwordx4 v5, s[4:7], s24 offen lds
    s_add_u32 m0, s27, 102400
    s_nop 0
    buffer_load_dwordx4 v6, s[4:7], s24 offen lds
    s_add_u32 m0, s27, 106496
    s_nop 0
    buffer_load_dwordx4 v7, s[8:11], s25 offen lds
    s_add_u32 m0, s27, 110592
    v_mfma_f32_32x32x16_bf16 v[68:83], v[40:43], v[48:51], v[68:83]
    buffer_load_dwordx4 v8, s[8:11], s25 offen lds
    s_add_u32 m0, s27, 114688
    s_nop 0
    buffer_load_dwordx4 v9, s[8:11], s25 offen lds
    s_add_u32 m0, s27, 118784
    s_nop 0
    buffer_load_dwordx4 v10, s[8:11], s25 offen lds
    s_add_u32 s24, s24, 128
    s_add_u32 s25, s25, 128
    ds_read_b128 v[36:39], v12 offset:24576
    ds_read_b128 v[40:43], v12 offset:28672
    ds_read_b128 v[48:51], v20 offset:24576
    s_waitcnt lgkmcnt(3)
    v_mfma_f32_32x32x16_bf16 v[52:67], v[28:31], v[44:47], v[52:67]
    v_mfma_f32_32x32x16_bf16 v[68:83], v[32:35], v[44:47], v[68:83]
    ds_read_b128 v[28:31], v13 offset:24576
    ds_read_b128 v[32:35], v13 offset:28672
    ds_read_b128 v[44:47], v21 offset:24576
    s_waitcnt lgkmcnt(3)
    v_mfma_f32_32x32x16_bf16 v[52:67], v[36:39], v[48:51], v[52:67]
    v_mfma_f32_32x32x16_bf16 v[68:83], v[40:43], v[48:51], v[68:83]
    ds_read_b128 v[36:39], v14 offset:24576
    ds_read_b128 v[40:43], v14 offset:28672
    ds_read_b128 v[48:51], v22 offset:24576
    s_waitcnt lgkmcnt(3)
    v_mfma_f32_32x32x16_bf16 v[52:67], v[28:31], v[44:47], v[52:67]
    v_mfma_f32_32x32x16_bf16 v[68:83], v[32:35], v[44:47], v[68:83]
    s_waitcnt vmcnt(12)
    s_barrier
    ds_read_b128 v[28:31], v11 offset:49152
    ds_read_b128 v[32:35], v11 offset:53248
    ds_read_b128 v[44:47], v19 offset:49152
    s_waitcnt lgkmcnt(3)
    s_mov_b32 m0, s27
    v_mfma_f32_32x32x16_bf16 v[52:67], v[36:39], v[48:51], v[52:67]
    buffer_load_dwordx4 v5, s[4:7], s24 offen lds
    s_add_u32 m0, s27, 4096
    s_nop 0
    buffer_load_dwordx4 v6, s[4:7], s24 offen lds
    s_add_u32 m0, s27, 8192
    s_nop 0
    buffer_load_dwordx4 v7, s[8:11], s25 offen lds
    s_add_u32 m0, s27, 12288
    v_mfma_f32_32x32x16_bf16 v[68:83], v[40:43], v[48:51], v[68:83]
    buffer_load_dwordx4 v8, s[8:11], s25 offen lds
    s_add_u32 m0, s27, 16384
    s_nop 0
    buffer_load_dwordx4 v9, s[8:11], s25 offen lds
    s_add_u32 m0, s27, 20480
    s_nop 0
    buffer_load_dwordx4 v10, s[8:11], s25 offen lds
    s_add_u32 s24, s24, 128
    s_add_u32 s25, s25, 128
    ds_read_b128 v[36:39], v12 offset:49152
    ds_read_b128 v[40:43], v12 offset:53248
    ds_read_b128 v[48:51], v20 offset:49152
    s_waitcnt lgkmcnt(3)
    v_mfma_f32_32x32x16_bf16 v[52:67], v[28:31], v[44:47], v[52:67]
    v_mfma_f32_32x32x16_bf16 v[68:83], v[32:35], v[44:47], v[68:83]
    ds_read_b128 v[28:31], v13 offset:49152
    ds_read_b128 v[32:35], v13 offset:53248
    ds_read_b128 v[44:47], v21 offset:49152
    s_waitcnt lgkmcnt(3)
    v_mfma_f32_32x32x16_bf16 v[52:67], v[36:39], v[48:51], v[52:67]
    v_mfma_f32_32x32x16_bf16 v[68:83], v[40:43], v[48:51], v[68:83]
    ds_read_b128 v[36:39], v14 offset:49152
    ds_read_b128 v[40:43], v14 offset:53248
    ds_read_b128 v[48:51], v22 offset:49152
    s_waitcnt lgkmcnt(3)
    v_mfma_f32_32x32x16_bf16 v[52:67], v[28:31], v[44:47], v[52:67]
    v_mfma_f32_32x32x16_bf16 v[68:83], v[32:35], v[44:47], v[68:83]
    s_waitcnt vmcnt(12)
    s_barrier
    ds_read_b128 v[28:31], v15 offset:8192
    ds_read_b128 v[32:35], v15 offset:12288
    ds_read_b128 v[44:47], v23 offset:8192
    s_waitcnt lgkmcnt(3)
    s_add_u32 m0, s27, 24576
    v_mfma_f32_32x32x16_bf16 v[52:67], v[36:39], v[48:51], v[52:67]
    buffer_load_dwordx4 v5, s[4:7], s24 offen lds
    s_add_u32 m0, s27, 28672
    s_nop 0
    buffer_load_dwordx4 v6, s[4:7], s24 offen lds
    s_add_u32 m0, s27, 32768
    s_nop 0
    buffer_load_dwordx4 v7, s[8:11], s25 offen lds
    s_add_u32 m0, s27, 36864
    v_mfma_f32_32x32x16_bf16 v[68:83], v[40:43], v[48:51], v[68:83]
    buffer_load_dwordx4 v8, s[8:11], s25 offen lds
    s_add_u32 m0, s27, 40960
    s_nop 0
    buffer_load_dwordx4 v9, s[8:11], s25 offen lds
    s_add_u32 m0, s27, 45056
    s_nop 0
    buffer_load_dwordx4 v10, s[8:11], s25 offen lds
    s_add_u32 s24, s24, 128
    s_add_u32 s25, s25, 128
    ds_read_b128 v[36:39], v16 offset:8192
    ds_read_b128 v[40:43], v16 offset:12288
    ds_read_b128 v[48:51], v24 offset:8192
    s_waitcnt lgkmcnt(3)
    v_mfma_f32_32x32x16_bf16 v[52:67], v[28:31], v[44:47], v[52:67]
    v_mfma_f32_32x32x16_bf16 v[68:83], v[32:35], v[44:47], v[68:83]
    ds_read_b128 v[28:31], v17 offset:8192
    ds_read_b128 v[32:35], v17 offset:12288
    ds_read_b128 v[44:47], v25 offset:8192
    s_waitcnt lgkmcnt(3)
    v_mfma_f32_32x32x16_bf16 v[52:67], v[36:39], v[48:51], v[52:67]
    v_mfma_f32_32x32x16_bf16 v[68:83], v[40:43], v[48:51], v[68:83]
    ds_read_b128 v[36:39], v18 offset:8192
    ds_read_b128 v[40:43], v18 offset:12288
    ds_read_b128 v[48:51], v26 offset:8192
    s_waitcnt lgkmcnt(3)
    v_mfma_f32_32x32x16_bf16 v[52:67], v[28:31], v[44:47], v[52:67]
    v_mfma_f32_32x32x16_bf16 v[68:83], v[32:35], v[44:47], v[68:83]
    s_waitcnt vmcnt(12)
    s_barrier
    ds_read_b128 v[28:31], v15 offset:32768
    ds_read_b128 v[32:35], v15 offset:36864
    ds_read_b128 v[44:47], v23 offset:32768
    s_waitcnt lgkmcnt(3)
    s_add_u32 m0, s27, 49152
    v_mfma_f32_32x32x16_bf16 v[52:67], v[36:39], v[48:51], v[52:67]
    buffer_load_dwordx4 v5, s[4:7], s24 offen lds
    s_add_u32 m0, s27, 53248
    s_nop 0
    buffer_load_dwordx4 v6, s[4:7], s24 offen lds
    s_add_u32 m0, s27, 57344
    s_nop 0
    buffer_load_dwordx4 v7, s[8:11], s25 offen lds
    s_add_u32 m0, s27, 61440
    v_mfma_f32_32x32x16_bf16 v[68:83], v[40:43], v[48:51], v[68:83]
    buffer_load_dwordx4 v8, s[8:11], s25 offen lds
    s_add_u32 m0, s27, 65536
    s_nop 0
    buffer_load_dwordx4 v9, s[8:11], s25 offen lds
    s_add_u32 m0, s27, 69632
    s_nop 0
    buffer_load_dwordx4 v10, s[8:11], s25 offen lds
    s_add_u32 s24, s24, 128
    s_add_u32 s25, s25, 128
    ds_read_b128 v[36:39], v16 offset:32768
    ds_read_b128 v[40:43], v16 offset:36864
    ds_read_b128 v[48:51], v24 offset:32768
    s_waitcnt lgkmcnt(3)
    v_mfma_f32_32x32x16_bf16 v[52:67], v[28:31], v[44:47], v[52:67]
    v_mfma_f32_32x32x16_bf16 v[68:83], v[32:35], v[44:47], v[68:83]
    ds_read_b128 v[28:31], v17 offset:32768
    ds_read_b128 v[32:35], v17 offset:36864
    ds_read_b128 v[44:47], v25 offset:32768
    s_waitcnt lgkmcnt(3)
    v_mfma_f32_32x32x16_bf16 v[52:67], v[36:39], v[48:51], v[52:67]
    v_mfma_f32_32x32x16_bf16 v[68:83], v[40:43], v[48:51], v[68:83]
    ds_read_b128 v[36:39], v18 offset:32768
    ds_read_b128 v[40:43], v18 offset:36864
    ds_read_b128 v[48:51], v26 offset:32768
    s_waitcnt lgkmcnt(3)
    v_mfma_f32_32x32x16_bf16 v[52:67], v[28:31], v[44:47], v[52:67]
    v_mfma_f32_32x32x16_bf16 v[68:83], v[32:35], v[44:47], v[68:83]
    s_waitcnt vmcnt(12)
    s_barrier
    ds_read_b128 v[28:31], v11 offset:0
    ds_read_b128 v[32:35], v11 offset:4096
    ds_read_b128 v[44:47], v19 offset:0
    s_waitcnt lgkmcnt(3)
    s_add_u32 m0, s27, 73728
    v_mfma_f32_32x32x16_bf16 v[52:67], v[36:39], v[48:51], v[52:67]
    buffer_load_dwordx4 v5, s[4:7], s24 offen lds
    s_add_u32 m0, s27, 77824
    s_nop 0
    buffer_load_dwordx4 v6, s[4:7], s24 offen lds
    s_add_u32 m0, s27, 81920
    s_nop 0
    buffer_load_dwordx4 v7, s[8:11], s25 offen lds
    s_add_u32 m0, s27, 86016
    v_mfma_f32_32x32x16_bf16 v[68:83], v[40:43], v[48:51], v[68:83]
    buffer_load_dwordx4 v8, s[8:11], s25 offen lds
    s_add_u32 m0, s27, 90112
    s_nop 0
    buffer_load_dwordx4 v9, s[8:11], s25 offen lds
    s_add_u32 m0, s27, 94208
    s_nop 0
    buffer_load_dwordx4 v10, s[8:11], s25 offen lds
    s_add_u32 s24, s24, 128
    s_add_u32 s25, s25, 128
    ds_read_b128 v[36:39], v12 offset:0
    ds_read_b128 v[40:43], v12 offset:4096
    ds_read_b128 v[48:51], v20 offset:0
    s_waitcnt lgkmcnt(3)
    v_mfma_f32_32x32x16_bf16 v[52:67], v[28:31], v[44:47], v[52:67]
    v_mfma_f32_32x32x16_bf16 v[68:83], v[32:35], v[44:47], v[68:83]
    ds_read_b128 v[28:31], v13 offset:0
    ds_read_b128 v[32:35], v13 offset:4096
    ds_read_b128 v[44:47], v21 offset:0
    s_waitcnt lgkmcnt(3)
    v_mfma_f32_32x32x16_bf16 v[52:67], v[36:39], v[48:51], v[52:67]
    v_mfma_f32_32x32x16_bf16 v[68:83], v[40:43], v[48:51], v[68:83]
    ds_read_b128 v[36:39], v14 offset:0
    ds_read_b128 v[40:43], v14 offset:4096
    ds_read_b128 v[48:51], v22 offset:0
    s_waitcnt lgkmcnt(3)
    v_mfma_f32_32x32x16_bf16 v[52:67], v[28:31], v[44:47], v[52:67]
    v_mfma_f32_32x32x16_bf16 v[68:83], v[32:35], v[44:47], v[68:83]
    s_waitcnt vmcnt(12)
    s_barrier
    ds_read_b128 v[28:31], v11 offset:24576
    ds_read_b128 v[32:35], v11 offset:28672
    ds_read_b128 v[44:47], v19 offset:24576
    s_waitcnt lgkmcnt(3)
    s_add_u32 m0, s27, 98304
    v_mfma_f32_32x32x16_bf16 v[52:67], v[36:39], v[48:51], v[52:67]
    buffer_load_dwordx4 v5, s[4:7], s24 offen lds
    s_add_u32 m0, s27, 102400
    s_nop 0
    buffer_load_dwordx4 v6, s[4:7], s24 offen lds
    s_add_u32 m0, s27, 106496
    s_nop 0
    buffer_load_dwordx4 v7, s[8:11], s25 offen lds
    s_add_u32 m0, s27, 110592
    v_mfma_f32_32x32x16_bf16 v[68:83], v[40:43], v[48:51], v[68:83]
    buffer_load_dwordx4 v8, s[8:11], s25 offen lds
    s_add_u32 m0, s27, 114688
    s_nop 0
    buffer_load_dwordx4 v9, s[8:11], s25 offen lds
    s_add_u32 m0, s27, 118784
    s_nop 0
    buffer_load_dwordx4 v10, s[8:11], s25 offen lds
    s_add_u32 s24, s24, 128
    s_add_u32 s25, s25, 128
    ds_read_b128 v[36:39], v12 offset:24576
    ds_read_b128 v[40:43], v12 offset:28672
    ds_read_b128 v[48:51], v20 offset:24576
    s_waitcnt lgkmcnt(3)
    v_mfma_f32_32x32x16_bf16 v[52:67], v[28:31], v[44:47], v[52:67]
    v_mfma_f32_32x32x16_bf16 v[68:83], v[32:35], v[44:47], v[68:83]
    ds_read_b128 v[28:31], v13 offset:24576
    ds_read_b128 v[32:35], v13 offset:28672
    ds_read_b128 v[44:47], v21 offset:24576
    s_waitcnt lgkmcnt(3)
    v_mfma_f32_32x32x16_bf16 v[52:67], v[36:39], v[48:51], v[52:67]
    v_mfma_f32_32x32x16_bf16 v[68:83], v[40:43], v[48:51], v[68:83]
    ds_read_b128 v[36:39], v14 offset:24576
    ds_read_b128 v[40:43], v14 offset:28672
    ds_read_b128 v[48:51], v22 offset:24576
    s_waitcnt lgkmcnt(3)
    v_mfma_f32_32x32x16_bf16 v[52:67], v[28:31], v[44:47], v[52:67]
    v_mfma_f32_32x32x16_bf16 v[68:83], v[32:35], v[44:47], v[68:83]
    s_waitcnt vmcnt(12)
    s_barrier
    ds_read_b128 v[28:31], v11 offset:49152
    ds_read_b128 v[32:35], v11 offset:53248
    ds_read_b128 v[44:47], v19 offset:49152
    s_waitcnt lgkmcnt(3)
    s_mov_b32 m0, s27
    v_mfma_f32_32x32x16_bf16 v[52:67], v[36:39], v[48:51], v[52:67]
    buffer_load_dwordx4 v5, s[4:7], s24 offen lds
    s_add_u32 m0, s27, 4096
    s_nop 0
    buffer_load_dwordx4 v6, s[4:7], s24 offen lds
    s_add_u32 m0, s27, 8192
    s_nop 0
    buffer_load_dwordx4 v7, s[8:11], s25 offen lds
    s_add_u32 m0, s27, 12288
    v_mfma_f32_32x32x16_bf16 v[68:83], v[40:43], v[48:51], v[68:83]
    buffer_load_dwordx4 v8, s[8:11], s25 offen lds
    s_add_u32 m0, s27, 16384
    s_nop 0
    buffer_load_dwordx4 v9, s[8:11], s25 offen lds
    s_add_u32 m0, s27, 20480
    s_nop 0
    buffer_load_dwordx4 v10, s[8:11], s25 offen lds
    s_add_u32 s24, s24, 128
    s_add_u32 s25, s25, 128
    ds_read_b128 v[36:39], v12 offset:49152
    ds_read_b128 v[40:43], v12 offset:53248
    ds_read_b128 v[48:51], v20 offset:49152
    s_waitcnt lgkmcnt(3)
    v_mfma_f32_32x32x16_bf16 v[52:67], v[28:31], v[44:47], v[52:67]
    v_mfma_f32_32x32x16_bf16 v[68:83], v[32:35], v[44:47], v[68:83]
    ds_read_b128 v[28:31], v13 offset:49152
    ds_read_b128 v[32:35], v13 offset:53248
    ds_read_b128 v[44:47], v21 offset:49152
    s_waitcnt lgkmcnt(3)
    v_mfma_f32_32x32x16_bf16 v[52:67], v[36:39], v[48:51], v[52:67]
    v_mfma_f32_32x32x16_bf16 v[68:83], v[40:43], v[48:51], v[68:83]
    ds_read_b128 v[36:39], v14 offset:49152
    ds_read_b128 v[40:43], v14 offset:53248
    ds_read_b128 v[48:51], v22 offset:49152
    s_waitcnt lgkmcnt(3)
    v_mfma_f32_32x32x16_bf16 v[52:67], v[28:31], v[44:47], v[52:67]
    v_mfma_f32_32x32x16_bf16 v[68:83], v[32:35], v[44:47], v[68:83]
    s_waitcnt vmcnt(12)
    s_barrier
    ds_read_b128 v[28:31], v15 offset:8192
    ds_read_b128 v[32:35], v15 offset:12288
    ds_read_b128 v[44:47], v23 offset:8192
    s_waitcnt lgkmcnt(3)
    s_add_u32 m0, s27, 24576
    v_mfma_f32_32x32x16_bf16 v[52:67], v[36:39], v[48:51], v[52:67]
    buffer_load_dwordx4 v5, s[4:7], s24 offen lds
    s_add_u32 m0, s27, 28672
    s_nop 0
    buffer_load_dwordx4 v6, s[4:7], s24 offen lds
    s_add_u32 m0, s27, 32768
    s_nop 0
    buffer_load_dwordx4 v7, s[8:11], s25 offen lds
    s_add_u32 m0, s27, 36864
    v_mfma_f32_32x32x16_bf16 v[68:83], v[40:43], v[48:51], v[68:83]
    buffer_load_dwordx4 v8, s[8:11], s25 offen lds
    s_add_u32 m0, s27, 40960
    s_nop 0
    buffer_load_dwordx4 v9, s[8:11], s25 offen lds
    s_add_u32 m0, s27, 45056
    s_nop 0
    buffer_load_dwordx4 v10, s[8:11], s25 offen lds
    s_add_u32 s24, s24, 128
    s_add_u32 s25, s25, 128
    ds_read_b128 v[36:39], v16 offset:8192
    ds_read_b128 v[40:43], v16 offset:12288
    ds_read_b128 v[48:51], v24 offset:8192
    s_waitcnt lgkmcnt(3)
    v_mfma_f32_32x32x16_bf16 v[52:67], v[28:31], v[44:47], v[52:67]
    v_mfma_f32_32x32x16_bf16 v[68:83], v[32:35], v[44:47], v[68:83]
    ds_read_b128 v[28:31], v17 offset:8192
    ds_read_b128 v[32:35], v17 offset:12288
    ds_read_b128 v[44:47], v25 offset:8192
    s_waitcnt lgkmcnt(3)
    v_mfma_f32_32x32x16_bf16 v[52:67], v[36:39], v[48:51], v[52:67]
    v_mfma_f32_32x32x16_bf16 v[68:83], v[40:43], v[48:51], v[68:83]
    ds_read_b128 v[36:39], v18 offset:8192
    ds_read_b128 v[40:43], v18 offset:12288
    ds_read_b128 v[48:51], v26 offset:8192
    s_waitcnt lgkmcnt(3)
    v_mfma_f32_32x32x16_bf16 v[52:67], v[28:31], v[44:47], v[52:67]
    v_mfma_f32_32x32x16_bf16 v[68:83], v[32:35], v[44:47], v[68:83]
    s_waitcnt vmcnt(12)
    s_barrier
    ds_read_b128 v[28:31], v15 offset:32768
    ds_read_b128 v[32:35], v15 offset:36864
    ds_read_b128 v[44:47], v23 offset:32768
    s_waitcnt lgkmcnt(3)
    s_add_u32 m0, s27, 49152
    v_mfma_f32_32x32x16_bf16 v[52:67], v[36:39], v[48:51], v[52:67]
    buffer_load_dwordx4 v5, s[4:7], s24 offen lds
    s_add_u32 m0, s27, 53248
    s_nop 0
    buffer_load_dwordx4 v6, s[4:7], s24 offen lds
    s_add_u32 m0, s27, 57344
    s_nop 0
    buffer_load_dwordx4 v7, s[8:11], s25 offen lds
    s_add_u32 m0, s27, 61440
    v_mfma_f32_32x32x16_bf16 v[68:83], v[40:43], v[48:51], v[68:83]
    buffer_load_dwordx4 v8, s[8:11], s25 offen lds
    s_add_u32 m0, s27, 65536
    s_nop 0
    buffer_load_dwordx4 v9, s[8:11], s25 offen lds
    s_add_u32 m0, s27, 69632
    s_nop 0
    buffer_load_dwordx4 v10, s[8:11], s25 offen lds
    s_add_u32 s24, s24, 128
    s_add_u32 s25, s25, 128
    ds_read_b128 v[36:39], v16 offset:32768
    ds_read_b128 v[40:43], v16 offset:36864
    ds_read_b128 v[48:51], v24 offset:32768
    s_waitcnt lgkmcnt(3)
    v_mfma_f32_32x32x16_bf16 v[52:67], v[28:31], v[44:47], v[52:67]
    v_mfma_f32_32x32x16_bf16 v[68:83], v[32:35], v[44:47], v[68:83]
    ds_read_b128 v[28:31], v17 offset:32768
    ds_read_b128 v[32:35], v17 offset:36864
    ds_read_b128 v[44:47], v25 offset:32768
    s_waitcnt lgkmcnt(3)
    v_mfma_f32_32x32x16_bf16 v[52:67], v[36:39], v[48:51], v[52:67]
    v_mfma_f32_32x32x16_bf16 v[68:83], v[40:43], v[48:51], v[68:83]
    ds_read_b128 v[36:39], v18 offset:32768
    ds_read_b128 v[40:43], v18 offset:36864
    ds_read_b128 v[48:51], v26 offset:32768
    s_waitcnt lgkmcnt(3)
    v_mfma_f32_32x32x16_bf16 v[52:67], v[28:31], v[44:47], v[52:67]
    v_mfma_f32_32x32x16_bf16 v[68:83], v[32:35], v[44:47], v[68:83]
    s_waitcnt vmcnt(12)
    s_barrier
    ds_read_b128 v[28:31], v11 offset:0
    ds_read_b128 v[32:35], v11 offset:4096
    ds_read_b128 v[44:47], v19 offset:0
    s_waitcnt lgkmcnt(3)
    s_add_u32 m0, s27, 73728
    v_mfma_f32_32x32x16_bf16 v[52:67], v[36:39], v[48:51], v[52:67]
    buffer_load_dwordx4 v5, s[4:7], s24 offen lds
    s_add_u32 m0, s27, 77824
    s_nop 0
    buffer_load_dwordx4 v6, s[4:7], s24 offen lds
    s_add_u32 m0, s27, 81920
    s_nop 0
    buffer_load_dwordx4 v7, s[8:11], s25 offen lds
    s_add_u32 m0, s27, 86016
    v_mfma_f32_32x32x16_bf16 v[68:83], v[40:43], v[48:51], v[68:83]
    buffer_load_dwordx4 v8, s[8:11], s25 offen lds
    s_add_u32 m0, s27, 90112
    s_nop 0
    buffer_load_dwordx4 v9, s[8:11], s25 offen lds
    s_add_u32 m0, s27, 94208
    s_nop 0
    buffer_load_dwordx4 v10, s[8:11], s25 offen lds
    s_add_u32 s24, s24, 128
    s_add_u32 s25, s25, 128
    ds_read_b128 v[36:39], v12 offset:0
    ds_read_b128 v[40:43], v12 offset:4096
    ds_read_b128 v[48:51], v20 offset:0
    s_waitcnt lgkmcnt(3)
    v_mfma_f32_32x32x16_bf16 v[52:67], v[28:31], v[44:47], v[52:67]
    v_mfma_f32_32x32x16_bf16 v[68:83], v[32:35], v[44:47], v[68:83]
    ds_read_b128 v[28:31], v13 offset:0
    ds_read_b128 v[32:35], v13 offset:4096
    ds_read_b128 v[44:47], v21 offset:0
    s_waitcnt lgkmcnt(3)
    v_mfma_f32_32x32x16_bf16 v[52:67], v[36:39], v[48:51], v[52:67]
    v_mfma_f32_32x32x16_bf16 v[68:83], v[40:43], v[48:51], v[68:83]
    ds_read_b128 v[36:39], v14 offset:0
    ds_read_b128 v[40:43], v14 offset:4096
    ds_read_b128 v[48:51], v22 offset:0
    s_waitcnt lgkmcnt(3)
    v_mfma_f32_32x32x16_bf16 v[52:67], v[28:31], v[44:47], v[52:67]
    v_mfma_f32_32x32x16_bf16 v[68:83], v[32:35], v[44:47], v[68:83]
    s_waitcnt vmcnt(12)
    s_barrier
    ds_read_b128 v[28:31], v11 offset:24576
    ds_read_b128 v[32:35], v11 offset:28672
    ds_read_b128 v[44:47], v19 offset:24576
    s_waitcnt lgkmcnt(3)
    s_add_u32 m0, s27, 98304
    v_mfma_f32_32x32x16_bf16 v[52:67], v[36:39], v[48:51], v[52:67]
    buffer_load_dwordx4 v5, s[4:7], s24 offen lds
    s_add_u32 m0, s27, 102400
    s_nop 0
    buffer_load_dwordx4 v6, s[4:7], s24 offen lds
    s_add_u32 m0, s27, 106496
    s_nop 0
    buffer_load_dwordx4 v7, s[8:11], s25 offen lds
    s_add_u32 m0, s27, 110592
    v_mfma_f32_32x32x16_bf16 v[68:83], v[40:43], v[48:51], v[68:83]
    buffer_load_dwordx4 v8, s[8:11], s25 offen lds
    s_add_u32 m0, s27, 114688
    s_nop 0
    buffer_load_dwordx4 v9, s[8:11], s25 offen lds
    s_add_u32 m0, s27, 118784
    s_nop 0
    buffer_load_dwordx4 v10, s[8:11], s25 offen lds
    s_add_u32 s24, s24, 128
    s_add_u32 s25, s25, 128
    ds_read_b128 v[36:39], v12 offset:24576
    ds_read_b128 v[40:43], v12 offset:28672
    ds_read_b128 v[48:51], v20 offset:24576
    s_waitcnt lgkmcnt(3)
    v_mfma_f32_32x32x16_bf16 v[52:67], v[28:31], v[44:47], v[52:67]
    v_mfma_f32_32x32x16_bf16 v[68:83], v[32:35], v[44:47], v[68:83]
    ds_read_b128 v[28:31], v13 offset:24576
    ds_read_b128 v[32:35], v13 offset:28672
    ds_read_b128 v[44:47], v21 offset:24576
    s_waitcnt lgkmcnt(3)
    v_mfma_f32_32x32x16_bf16 v[52:67], v[36:39], v[48:51], v[52:67]
    v_mfma_f32_32x32x16_bf16 v[68:83], v[40:43], v[48:51], v[68:83]
    ds_read_b128 v[36:39], v14 offset:24576
    ds_read_b128 v[40:43], v14 offset:28672
    ds_read_b128 v[48:51], v22 offset:24576
    s_waitcnt lgkmcnt(3)
    v_mfma_f32_32x32x16_bf16 v[52:67], v[28:31], v[44:47], v[52:67]
    v_mfma_f32_32x32x16_bf16 v[68:83], v[32:35], v[44:47], v[68:83]
    s_waitcnt vmcnt(12)
    s_barrier
    ds_read_b128 v[28:31], v11 offset:49152
    ds_read_b128 v[32:35], v11 offset:53248
    ds_read_b128 v[44:47], v19 offset:49152
    s_waitcnt lgkmcnt(3)
    s_mov_b32 m0, s27
    v_mfma_f32_32x32x16_bf16 v[52:67], v[36:39], v[48:51], v[52:67]
    buffer_load_dwordx4 v5, s[4:7], s24 offen lds
    s_add_u32 m0, s27, 4096
    s_nop 0
    buffer_load_dwordx4 v6, s[4:7], s24 offen lds
    s_add_u32 m0, s27, 8192
    s_nop 0
    buffer_load_dwordx4 v7, s[8:11], s25 offen lds
    s_add_u32 m0, s27, 12288
    v_mfma_f32_32x32x16_bf16 v[68:83], v[40:43], v[48:51], v[68:83]
    buffer_load_dwordx4 v8, s[8:11], s25 offen lds
    s_add_u32 m0, s27, 16384
    s_nop 0
    buffer_load_dwordx4 v9, s[8:11], s25 offen lds
    s_add_u32 m0, s27, 20480
    s_nop 0
    buffer_load_dwordx4 v10, s[8:11], s25 offen lds
    s_add_u32 s24, s24, 128
    s_add_u32 s25, s25, 128
    ds_read_b128 v[36:39], v12 offset:49152
    ds_read_b128 v[40:43], v12 offset:53248
    ds_read_b128 v[48:51], v20 offset:49152
    s_waitcnt lgkmcnt(3)
    v_mfma_f32_32x32x16_bf16 v[52:67], v[28:31], v[44:47], v[52:67]
    v_mfma_f32_32x32x16_bf16 v[68:83], v[32:35], v[44:47], v[68:83]
    ds_read_b128 v[28:31], v13 offset:49152
    ds_read_b128 v[32:35], v13 offset:53248
    ds_read_b128 v[44:47], v21 offset:49152
    s_waitcnt lgkmcnt(3)
    v_mfma_f32_32x32x16_bf16 v[52:67], v[36:39], v[48:51], v[52:67]
    v_mfma_f32_32x32x16_bf16 v[68:83], v[40:43], v[48:51], v[68:83]
    ds_read_b128 v[36:39], v14 offset:49152
    ds_read_b128 v[40:43], v14 offset:53248
    ds_read_b128 v[48:51], v22 offset:49152
    s_waitcnt lgkmcnt(3)
    v_mfma_f32_32x32x16_bf16 v[52:67], v[28:31], v[44:47], v[52:67]
    v_mfma_f32_32x32x16_bf16 v[68:83], v[32:35], v[44:47], v[68:83]
    s_waitcnt vmcnt(12)
    s_barrier
    ds_read_b128 v[28:31], v15 offset:8192
    ds_read_b128 v[32:35], v15 offset:12288
    ds_read_b128 v[44:47], v23 offset:8192
    s_waitcnt lgkmcnt(3)
    s_add_u32 m0, s27, 24576
    v_mfma_f32_32x32x16_bf16 v[52:67], v[36:39], v[48:51], v[52:67]
    buffer_load_dwordx4 v5, s[4:7], s24 offen lds
    s_add_u32 m0, s27, 28672
    s_nop 0
    buffer_load_dwordx4 v6, s[4:7], s24 offen lds
    s_add_u32 m0, s27, 32768
    s_nop 0
    buffer_load_dwordx4 v7, s[8:11], s25 offen lds
    s_add_u32 m0, s27, 36864
    v_mfma_f32_32x32x16_bf16 v[68:83], v[40:43], v[48:51], v[68:83]
    buffer_load_dwordx4 v8, s[8:11], s25 offen lds
    s_add_u32 m0, s27, 40960
    s_nop 0
    buffer_load_dwordx4 v9, s[8:11], s25 offen lds
    s_add_u32 m0, s27, 45056
    s_nop 0
    buffer_load_dwordx4 v10, s[8:11], s25 offen lds
    s_add_u32 s24, s24, 128
    s_add_u32 s25, s25, 128
    ds_read_b128 v[36:39], v16 offset:8192
    ds_read_b128 v[40:43], v16 offset:12288
    ds_read_b128 v[48:51], v24 offset:8192
    s_waitcnt lgkmcnt(3)
    v_mfma_f32_32x32x16_bf16 v[52:67], v[28:31], v[44:47], v[52:67]
    v_mfma_f32_32x32x16_bf16 v[68:83], v[32:35], v[44:47], v[68:83]
    ds_read_b128 v[28:31], v17 offset:8192
    ds_read_b128 v[32:35], v17 offset:12288
    ds_read_b128 v[44:47], v25 offset:8192
    s_waitcnt lgkmcnt(3)
    v_mfma_f32_32x32x16_bf16 v[52:67], v[36:39], v[48:51], v[52:67]
    v_mfma_f32_32x32x16_bf16 v[68:83], v[40:43], v[48:51], v[68:83]
    ds_read_b128 v[36:39], v18 offset:8192
    ds_read_b128 v[40:43], v18 offset:12288
    ds_read_b128 v[48:51], v26 offset:8192
    s_waitcnt lgkmcnt(3)
    v_mfma_f32_32x32x16_bf16 v[52:67], v[28:31], v[44:47], v[52:67]
    v_mfma_f32_32x32x16_bf16 v[68:83], v[32:35], v[44:47], v[68:83]
    s_waitcnt vmcnt(12)
    s_barrier
    ds_read_b128 v[28:31], v15 offset:32768
    ds_read_b128 v[32:35], v15 offset:36864
    ds_read_b128 v[44:47], v23 offset:32768
    s_waitcnt lgkmcnt(3)
    s_add_u32 m0, s27, 49152
    v_mfma_f32_32x32x16_bf16 v[52:67], v[36:39], v[48:51], v[52:67]
    buffer_load_dwordx4 v5, s[4:7], s24 offen lds
    s_add_u32 m0, s27, 53248
    s_nop 0
    buffer_load_dwordx4 v6, s[4:7], s24 offen lds
    s_add_u32 m0, s27, 57344
    s_nop 0
    buffer_load_dwordx4 v7, s[8:11], s25 offen lds
    s_add_u32 m0, s27, 61440
    v_mfma_f32_32x32x16_bf16 v[68:83], v[40:43], v[48:51], v[68:83]
    buffer_load_dwordx4 v8, s[8:11], s25 offen lds
    s_add_u32 m0, s27, 65536
    s_nop 0
    buffer_load_dwordx4 v9, s[8:11], s25 offen lds
    s_add_u32 m0, s27, 69632
    s_nop 0
    buffer_load_dwordx4 v10, s[8:11], s25 offen lds
    s_add_u32 s24, s24, 128
    s_add_u32 s25, s25, 128
    ds_read_b128 v[36:39], v16 offset:32768
    ds_read_b128 v[40:43], v16 offset:36864
    ds_read_b128 v[48:51], v24 offset:32768
    s_waitcnt lgkmcnt(3)
    v_mfma_f32_32x32x16_bf16 v[52:67], v[28:31], v[44:47], v[52:67]
    v_mfma_f32_32x32x16_bf16 v[68:83], v[32:35], v[44:47], v[68:83]
    ds_read_b128 v[28:31], v17 offset:32768
    ds_read_b128 v[32:35], v17 offset:36864
    ds_read_b128 v[44:47], v25 offset:32768
    s_waitcnt lgkmcnt(3)
    v_mfma_f32_32x32x16_bf16 v[52:67], v[36:39], v[48:51], v[52:67]
    v_mfma_f32_32x32x16_bf16 v[68:83], v[40:43], v[48:51], v[68:83]
    ds_read_b128 v[36:39], v18 offset:32768
    ds_read_b128 v[40:43], v18 offset:36864
    ds_read_b128 v[48:51], v26 offset:32768
    s_waitcnt lgkmcnt(3)
    v_mfma_f32_32x32x16_bf16 v[52:67], v[28:31], v[44:47], v[52:67]
    v_mfma_f32_32x32x16_bf16 v[68:83], v[32:35], v[44:47], v[68:83]
    s_waitcnt vmcnt(12)
    s_barrier
    ds_read_b128 v[28:31], v11 offset:0
    ds_read_b128 v[32:35], v11 offset:4096
    ds_read_b128 v[44:47], v19 offset:0
    s_waitcnt lgkmcnt(3)
    s_add_u32 m0, s27, 73728
    v_mfma_f32_32x32x16_bf16 v[52:67], v[36:39], v[48:51], v[52:67]
    buffer_load_dwordx4 v5, s[4:7], s24 offen lds
    s_add_u32 m0, s27, 77824
    s_nop 0
    buffer_load_dwordx4 v6, s[4:7], s24 offen lds
    s_add_u32 m0, s27, 81920
    s_nop 0
    buffer_load_dwordx4 v7, s[8:11], s25 offen lds
    s_add_u32 m0, s27, 86016
    v_mfma_f32_32x32x16_bf16 v[68:83], v[40:43], v[48:51], v[68:83]
    buffer_load_dwordx4 v8, s[8:11], s25 offen lds
    s_add_u32 m0, s27, 90112
    s_nop 0
    buffer_load_dwordx4 v9, s[8:11], s25 offen lds
    s_add_u32 m0, s27, 94208
    s_nop 0
    buffer_load_dwordx4 v10, s[8:11], s25 offen lds
    s_add_u32 s24, s24, 128
    s_add_u32 s25, s25, 128
    ds_read_b128 v[36:39], v12 offset:0
    ds_read_b128 v[40:43], v12 offset:4096
    ds_read_b128 v[48:51], v20 offset:0
    s_waitcnt lgkmcnt(3)
    v_mfma_f32_32x32x16_bf16 v[52:67], v[28:31], v[44:47], v[52:67]
    v_mfma_f32_32x32x16_bf16 v[68:83], v[32:35], v[44:47], v[68:83]
    ds_read_b128 v[28:31], v13 offset:0
    ds_read_b128 v[32:35], v13 offset:4096
    ds_read_b128 v[44:47], v21 offset:0
    s_waitcnt lgkmcnt(3)
    v_mfma_f32_32x32x16_bf16 v[52:67], v[36:39], v[48:51], v[52:67]
    v_mfma_f32_32x32x16_bf16 v[68:83], v[40:43], v[48:51], v[68:83]
    ds_read_b128 v[36:39], v14 offset:0
    ds_read_b128 v[40:43], v14 offset:4096
    ds_read_b128 v[48:51], v22 offset:0
    s_waitcnt lgkmcnt(3)
    v_mfma_f32_32x32x16_bf16 v[52:67], v[28:31], v[44:47], v[52:67]
    v_mfma_f32_32x32x16_bf16 v[68:83], v[32:35], v[44:47], v[68:83]
    s_waitcnt vmcnt(12)
    s_barrier
    ds_read_b128 v[28:31], v11 offset:24576
    ds_read_b128 v[32:35], v11 offset:28672
    ds_read_b128 v[44:47], v19 offset:24576
    s_waitcnt lgkmcnt(3)
    s_add_u32 m0, s27, 98304
    v_mfma_f32_32x32x16_bf16 v[52:67], v[36:39], v[48:51], v[52:67]
    buffer_load_dwordx4 v5, s[4:7], s24 offen lds
    s_add_u32 m0, s27, 102400
    s_nop 0
    buffer_load_dwordx4 v6, s[4:7], s24 offen lds
    s_add_u32 m0, s27, 106496
    s_nop 0
    buffer_load_dwordx4 v7, s[8:11], s25 offen lds
    s_add_u32 m0, s27, 110592
    v_mfma_f32_32x32x16_bf16 v[68:83], v[40:43], v[48:51], v[68:83]
    buffer_load_dwordx4 v8, s[8:11], s25 offen lds
    s_add_u32 m0, s27, 114688
    s_nop 0
    buffer_load_dwordx4 v9, s[8:11], s25 offen lds
    s_add_u32 m0, s27, 118784
    s_nop 0
    buffer_load_dwordx4 v10, s[8:11], s25 offen lds
    s_add_u32 s24, s24, 128
    s_add_u32 s25, s25, 128
    ds_read_b128 v[36:39], v12 offset:24576
    ds_read_b128 v[40:43], v12 offset:28672
    ds_read_b128 v[48:51], v20 offset:24576
    s_waitcnt lgkmcnt(3)
    v_mfma_f32_32x32x16_bf16 v[52:67], v[28:31], v[44:47], v[52:67]
    v_mfma_f32_32x32x16_bf16 v[68:83], v[32:35], v[44:47], v[68:83]
    ds_read_b128 v[28:31], v13 offset:24576
    ds_read_b128 v[32:35], v13 offset:28672
    ds_read_b128 v[44:47], v21 offset:24576
    s_waitcnt lgkmcnt(3)
    v_mfma_f32_32x32x16_bf16 v[52:67], v[36:39], v[48:51], v[52:67]
    v_mfma_f32_32x32x16_bf16 v[68:83], v[40:43], v[48:51], v[68:83]
    ds_read_b128 v[36:39], v14 offset:24576
    ds_read_b128 v[40:43], v14 offset:28672
    ds_read_b128 v[48:51], v22 offset:24576
    s_waitcnt lgkmcnt(3)
    v_mfma_f32_32x32x16_bf16 v[52:67], v[28:31], v[44:47], v[52:67]
    v_mfma_f32_32x32x16_bf16 v[68:83], v[32:35], v[44:47], v[68:83]
    s_waitcnt vmcnt(12)
    s_barrier
    ds_read_b128 v[28:31], v11 offset:49152
    ds_read_b128 v[32:35], v11 offset:53248
    ds_read_b128 v[44:47], v19 offset:49152
    s_waitcnt lgkmcnt(3)
    s_mov_b32 m0, s27
    v_mfma_f32_32x32x16_bf16 v[52:67], v[36:39], v[48:51], v[52:67]
    buffer_load_dwordx4 v5, s[4:7], s24 offen lds
    s_add_u32 m0, s27, 4096
    s_nop 0
    buffer_load_dwordx4 v6, s[4:7], s24 offen lds
    s_add_u32 m0, s27, 8192
    s_nop 0
    buffer_load_dwordx4 v7, s[8:11], s25 offen lds
    s_add_u32 m0, s27, 12288
    v_mfma_f32_32x32x16_bf16 v[68:83], v[40:43], v[48:51], v[68:83]
    buffer_load_dwordx4 v8, s[8:11], s25 offen lds
    s_add_u32 m0, s27, 16384
    s_nop 0
    buffer_load_dwordx4 v9, s[8:11], s25 offen lds
    s_add_u32 m0, s27, 20480
    s_nop 0
    buffer_load_dwordx4 v10, s[8:11], s25 offen lds
    s_add_u32 s24, s24, 128
    s_add_u32 s25, s25, 128
    ds_read_b128 v[36:39], v12 offset:49152
    ds_read_b128 v[40:43], v12 offset:53248
    ds_read_b128 v[48:51], v20 offset:49152
    s_waitcnt lgkmcnt(3)
    v_mfma_f32_32x32x16_bf16 v[52:67], v[28:31], v[44:47], v[52:67]
    v_mfma_f32_32x32x16_bf16 v[68:83], v[32:35], v[44:47], v[68:83]
    ds_read_b128 v[28:31], v13 offset:49152
    ds_read_b128 v[32:35], v13 offset:53248
    ds_read_b128 v[44:47], v21 offset:49152
    s_waitcnt lgkmcnt(3)
    v_mfma_f32_32x32x16_bf16 v[52:67], v[36:39], v[48:51], v[52:67]
    v_mfma_f32_32x32x16_bf16 v[68:83], v[40:43], v[48:51], v[68:83]
    ds_read_b128 v[36:39], v14 offset:49152
    ds_read_b128 v[40:43], v14 offset:53248
    ds_read_b128 v[48:51], v22 offset:49152
    s_waitcnt lgkmcnt(3)
    v_mfma_f32_32x32x16_bf16 v[52:67], v[28:31], v[44:47], v[52:67]
    v_mfma_f32_32x32x16_bf16 v[68:83], v[32:35], v[44:47], v[68:83]
    s_waitcnt vmcnt(12)
    s_barrier
    ds_read_b128 v[28:31], v15 offset:8192
    ds_read_b128 v[32:35], v15 offset:12288
    ds_read_b128 v[44:47], v23 offset:8192
    s_waitcnt lgkmcnt(3)
    s_add_u32 m0, s27, 24576
    v_mfma_f32_32x32x16_bf16 v[52:67], v[36:39], v[48:51], v[52:67]
    buffer_load_dwordx4 v5, s[4:7], s24 offen lds
    s_add_u32 m0, s27, 28672
    s_nop 0
    buffer_load_dwordx4 v6, s[4:7], s24 offen lds
    s_add_u32 m0, s27, 32768
    s_nop 0
    buffer_load_dwordx4 v7, s[8:11], s25 offen lds
    s_add_u32 m0, s27, 36864
    v_mfma_f32_32x32x16_bf16 v[68:83], v[40:43], v[48:51], v[68:83]
    buffer_load_dwordx4 v8, s[8:11], s25 offen lds
    s_add_u32 m0, s27, 40960
    s_nop 0
    buffer_load_dwordx4 v9, s[8:11], s25 offen lds
    s_add_u32 m0, s27, 45056
    s_nop 0
    buffer_load_dwordx4 v10, s[8:11], s25 offen lds
    s_add_u32 s24, s24, 128
    s_add_u32 s25, s25, 128
    ds_read_b128 v[36:39], v16 offset:8192
    ds_read_b128 v[40:43], v16 offset:12288
    ds_read_b128 v[48:51], v24 offset:8192
    s_waitcnt lgkmcnt(3)
    v_mfma_f32_32x32x16_bf16 v[52:67], v[28:31], v[44:47], v[52:67]
    v_mfma_f32_32x32x16_bf16 v[68:83], v[32:35], v[44:47], v[68:83]
    ds_read_b128 v[28:31], v17 offset:8192
    ds_read_b128 v[32:35], v17 offset:12288
    ds_read_b128 v[44:47], v25 offset:8192
    s_waitcnt lgkmcnt(3)
    v_mfma_f32_32x32x16_bf16 v[52:67], v[36:39], v[48:51], v[52:67]
    v_mfma_f32_32x32x16_bf16 v[68:83], v[40:43], v[48:51], v[68:83]
    ds_read_b128 v[36:39], v18 offset:8192
    ds_read_b128 v[40:43], v18 offset:12288
    ds_read_b128 v[48:51], v26 offset:8192
    s_waitcnt lgkmcnt(3)
    v_mfma_f32_32x32x16_bf16 v[52:67], v[28:31], v[44:47], v[52:67]
    v_mfma_f32_32x32x16_bf16 v[68:83], v[32:35], v[44:47], v[68:83]
    s_waitcnt vmcnt(12)
    s_barrier
    ds_read_b128 v[28:31], v15 offset:32768
    ds_read_b128 v[32:35], v15 offset:36864
    ds_read_b128 v[44:47], v23 offset:32768
    s_waitcnt lgkmcnt(3)
    v_mfma_f32_32x32x16_bf16 v[52:67], v[36:39], v[48:51], v[52:67]
    v_mfma_f32_32x32x16_bf16 v[68:83], v[40:43], v[48:51], v[68:83]
    ds_read_b128 v[36:39], v16 offset:32768
    ds_read_b128 v[40:43], v16 offset:36864
    ds_read_b128 v[48:51], v24 offset:32768
    s_waitcnt lgkmcnt(3)
    v_mfma_f32_32x32x16_bf16 v[52:67], v[28:31], v[44:47], v[52:67]
    v_mfma_f32_32x32x16_bf16 v[68:83], v[32:35], v[44:47], v[68:83]
    ds_read_b128 v[28:31], v17 offset:32768
    ds_read_b128 v[32:35], v17 offset:36864
    ds_read_b128 v[44:47], v25 offset:32768
    s_waitcnt lgkmcnt(3)
    v_mfma_f32_32x32x16_bf16 v[52:67], v[36:39], v[48:51], v[52:67]
    v_mfma_f32_32x32x16_bf16 v[68:83], v[40:43], v[48:51], v[68:83]
    ds_read_b128 v[36:39], v18 offset:32768
    ds_read_b128 v[40:43], v18 offset:36864
    ds_read_b128 v[48:51], v26 offset:32768
    s_waitcnt lgkmcnt(3)
    v_mfma_f32_32x32x16_bf16 v[52:67], v[28:31], v[44:47], v[52:67]
    v_mfma_f32_32x32x16_bf16 v[68:83], v[32:35], v[44:47], v[68:83]
    s_waitcnt vmcnt(6)
    s_barrier
    ds_read_b128 v[28:31], v11 offset:0
    ds_read_b128 v[32:35], v11 offset:4096
    ds_read_b128 v[44:47], v19 offset:0
    s_waitcnt lgkmcnt(3)
    v_mfma_f32_32x32x16_bf16 v[52:67], v[36:39], v[48:51], v[52:67]
    v_mfma_f32_32x32x16_bf16 v[68:83], v[40:43], v[48:51], v[68:83]
    ds_read_b128 v[36:39], v12 offset:0
    ds_read_b128 v[40:43], v12 offset:4096
    ds_read_b128 v[48:51], v20 offset:0
    s_waitcnt lgkmcnt(3)
    v_mfma_f32_32x32x16_bf16 v[52:67], v[28:31], v[44:47], v[52:67]
    v_mfma_f32_32x32x16_bf16 v[68:83], v[32:35], v[44:47], v[68:83]
    ds_read_b128 v[28:31], v13 offset:0
    ds_read_b128 v[32:35], v13 offset:4096
    ds_read_b128 v[44:47], v21 offset:0
    s_waitcnt lgkmcnt(3)
    v_mfma_f32_32x32x16_bf16 v[52:67], v[36:39], v[48:51], v[52:67]
    v_mfma_f32_32x32x16_bf16 v[68:83], v[40:43], v[48:51], v[68:83]
    ds_read_b128 v[36:39], v14 offset:0
    ds_read_b128 v[40:43], v14 offset:4096
    ds_read_b128 v[48:51], v22 offset:0
    s_waitcnt lgkmcnt(3)
    v_mfma_f32_32x32x16_bf16 v[52:67], v[28:31], v[44:47], v[52:67]
    v_mfma_f32_32x32x16_bf16 v[68:83], v[32:35], v[44:47], v[68:83]
    s_waitcnt vmcnt(0)
    s_barrier
    ds_read_b128 v[28:31], v11 offset:24576
    ds_read_b128 v[32:35], v11 offset:28672
    ds_read_b128 v[44:47], v19 offset:24576
    s_waitcnt lgkmcnt(3)
    v_mfma_f32_32x32x16_bf16 v[52:67], v[36:39], v[48:51], v[52:67]
    v_mfma_f32_32x32x16_bf16 v[68:83], v[40:43], v[48:51], v[68:83]
    ds_read_b128 v[36:39], v12 offset:24576
    ds_read_b128 v[40:43], v12 offset:28672
    ds_read_b128 v[48:51], v20 offset:24576
    s_waitcnt lgkmcnt(3)
    v_mfma_f32_32x32x16_bf16 v[52:67], v[28:31], v[44:47], v[52:67]
    v_mfma_f32_32x32x16_bf16 v[68:83], v[32:35], v[44:47], v[68:83]
    ds_read_b128 v[28:31], v13 offset:24576
    ds_read_b128 v[32:35], v13 offset:28672
    ds_read_b128 v[44:47], v21 offset:24576
    s_waitcnt lgkmcnt(3)
    v_mfma_f32_32x32x16_bf16 v[52:67], v[36:39], v[48:51], v[52:67]
    v_mfma_f32_32x32x16_bf16 v[68:83], v[40:43], v[48:51], v[68:83]
    ds_read_b128 v[36:39], v14 offset:24576
    ds_read_b128 v[40:43], v14 offset:28672
    ds_read_b128 v[48:51], v22 offset:24576
    s_waitcnt lgkmcnt(3)
    v_mfma_f32_32x32x16_bf16 v[52:67], v[28:31], v[44:47], v[52:67]
    v_mfma_f32_32x32x16_bf16 v[68:83], v[32:35], v[44:47], v[68:83]
    s_waitcnt lgkmcnt(0)
    v_mfma_f32_32x32x16_bf16 v[52:67], v[36:39], v[48:51], v[52:67]
    v_mfma_f32_32x32x16_bf16 v[68:83], v[40:43], v[48:51], v[68:83]
    s_nop 15
    v_and_b32 v84, 31, v1
    s_mul_i32 s30, s63, 32
    v_add_u32 v84, s30, v84
    s_mov_b32 s30, 1024
    v_mul_lo_u32 v84, v84, s30
    v_lshrrev_b32 v86, 5, v1
    v_lshlrev_b32 v86, 3, v86
    v_add_u32 v85, v84, v86
    v_add_u32 v84, v85, v86
    s_mul_i32 s33, s29, 1024
    s_mul_i32 s30, s62, 64
    s_add_u32 s30, s30, s28
    s_lshl_b32 s30, s30, 1
    s_add_u32 s33, s33, s30
    s_add_u32 s34, s33, 0
    v_cvt_pk_bf16_f32 v88, v52, v53
    v_cvt_pk_bf16_f32 v89, v54, v55
    v_cvt_pk_bf16_f32 v90, v56, v57
    v_cvt_pk_bf16_f32 v91, v58, v59
    s_nop 1
    v_permlane32_swap_b32 v88, v90
    v_permlane32_swap_b32 v89, v91
    buffer_store_dwordx4 v[88:91], v84, s[12:15], s34 offen offset:0
    v_cvt_pk_bf16_f32 v92, v60, v61
    v_cvt_pk_bf16_f32 v93, v62, v63
    v_cvt_pk_bf16_f32 v94, v64, v65
    v_cvt_pk_bf16_f32 v95, v66, v67
    s_nop 1
    v_permlane32_swap_b32 v92, v94
    v_permlane32_swap_b32 v93, v95
    buffer_store_dwordx4 v[92:95], v84, s[12:15], s34 offen offset:32
    v_cvt_pk_bf16_f32 v88, v68, v69
    v_cvt_pk_bf16_f32 v89, v70, v71
    v_cvt_pk_bf16_f32 v90, v72, v73
    v_cvt_pk_bf16_f32 v91, v74, v75
    s_nop 1
    v_permlane32_swap_b32 v88, v90
    v_permlane32_swap_b32 v89, v91
    buffer_store_dwordx4 v[88:91], v84, s[12:15], s34 offen offset:64
    v_cvt_pk_bf16_f32 v92, v76, v77
    v_cvt_pk_bf16_f32 v93, v78, v79
    v_cvt_pk_bf16_f32 v94, v80, v81
    v_cvt_pk_bf16_f32 v95, v82, v83
    s_nop 1
    v_permlane32_swap_b32 v92, v94
    v_permlane32_swap_b32 v93, v95
    buffer_store_dwordx4 v[92:95], v84, s[12:15], s34 offen offset:96
p2_kernel_end:
    s_endpgm
.globl p3_kernel
.p2align 8
.type p3_kernel,@function
p3_kernel:
    s_cmp_ge_u32 s2, 224
    s_cbranch_scc1 p3_kernel_end
    s_load_dwordx16 s[36:51], s[0:1], 0
    s_load_dwordx8 s[52:59], s[0:1], 64
    s_load_dwordx2 s[60:61], s[0:1], 96
    v_and_b32 v1, 63, v0
    v_lshrrev_b32 v2, 6, v0
    s_nop 0
    v_readfirstlane_b32 s26, v2
    s_nop 1
    s_lshl_b32 s27, s26, 10
    s_lshr_b32 s62, s26, 1
    s_and_b32 s63, s26, 1
    s_waitcnt lgkmcnt(0)
    s_and_b32 s30, s2, 7
    s_lshr_b32 s31, s2, 3
    s_lshl_b32 s30, s30, 1
    s_and_b32 s32, s31, 1
    s_add_u32 s30, s30, s32
    s_lshl_b32 s29, s30, 7
    s_lshr_b32 s31, s31, 1
    s_lshl_b32 s28, s31, 7
    s_mov_b32 s4, s60
    s_mov_b32 s5, s61
    s_mov_b32 s6, 1835008
    s_mov_b32 s7, 0x00020000
    s_add_u32 s8, s60, 4194304
    s_addc_u32 s9, s61, 0
    s_mov_b32 s10, 2097152
    s_mov_b32 s11, 0x00020000
    s_add_u32 s12, s60, 14680064
    s_addc_u32 s13, s61, 0
    s_mov_b32 s14, 7340032
    s_mov_b32 s15, 0x00020000
    s_mul_i32 s24, s28, 1024
    s_mul_i32 s25, s29, 1024
    v_lshrrev_b32 v2, 4, v1
    s_and_b32 s30, s26, 1
    s_lshl_b32 s30, s30, 2
    v_add_u32 v2, s30, v2
    v_and_b32 v3, 7, v1
    v_xor_b32 v2, v2, v3
    v_lshlrev_b32 v2, 4, v2
    v_lshrrev_b32 v3, 3, v1
    s_lshl_b32 s30, s26, 3
    v_add_u32 v3, s30, v3
    s_mov_b32 s31, 1024
    s_mov_b32 s32, 1024
    v_add_u32 v4, 0, v3
    v_mul_lo_u32 v5, v4, s31
    v_add_u32 v5, v5, v2
    v_add_u32 v4, 32, v3
    v_mul_lo_u32 v6, v4, s31
    v_add_u32 v6, v6, v2
    v_add_u32 v4, 64, v3
    v_mul_lo_u32 v7, v4, s31
    v_add_u32 v7, v7, v2
    v_add_u32 v4, 96, v3
    v_mul_lo_u32 v8, v4, s31
    v_add_u32 v8, v8, v2
    v_add_u32 v4, 0, v3
    v_mul_lo_u32 v9, v4, s32
    v_add_u32 v9, v9, v2
    v_add_u32 v4, 32, v3
    v_mul_lo_u32 v10, v4, s32
    v_add_u32 v10, v10, v2
    v_add_u32 v4, 64, v3
    v_mul_lo_u32 v11, v4, s32
    v_add_u32 v11, v11, v2
    v_add_u32 v4, 96, v3
    v_mul_lo_u32 v12, v4, s32
    v_add_u32 v12, v12, v2
    v_and_b32 v2, 31, v1
    v_lshrrev_b32 v3, 1, v2
    v_and_b32 v3, 7, v3
    v_lshrrev_b32 v4, 5, v1
    v_xor_b32 v3, v3, v4
    v_lshlrev_b32 v3, 4, v3
    v_lshlrev_b32 v2, 7, v2
    v_add_u32 v2, v2, v3
    s_mul_i32 s30, s62, 8192
    s_mul_i32 s31, s63, 8192
    s_add_u32 s31, s31, 16384
    v_xor_b32 v3, 0, v2
    v_add_u32 v13, s30, v3
    v_add_u32 v21, s31, v3
    v_add_u32 v17, 65536, v13
    v_add_u32 v25, 65536, v21
    v_xor_b32 v3, 32, v2
    v_add_u32 v14, s30, v3
    v_add_u32 v22, s31, v3
    v_add_u32 v18, 65536, v14
    v_add_u32 v26, 65536, v22
    v_xor_b32 v3, 64, v2
    v_add_u32 v15, s30, v3
    v_add_u32 v23, s31, v3
    v_add_u32 v19, 65536, v15
    v_add_u32 v27, 65536, v23
    v_xor_b32 v3, 96, v2
    v_add_u32 v16, s30, v3
    v_add_u32 v24, s31, v3
    v_add_u32 v20, 65536, v16
    v_add_u32 v28, 65536, v24
    s_mov_b32 m0, s27
    s_nop 0
    buffer_load_dwordx4 v5, s[4:7], s24 offen lds
    s_add_u32 m0, s27, 4096
    s_nop 0
    buffer_load_dwordx4 v6, s[4:7], s24 offen lds
    s_add_u32 m0, s27, 8192
    s_nop 0
    buffer_load_dwordx4 v7, s[4:7], s24 offen lds
    s_add_u32 m0, s27, 12288
    s_nop 0
    buffer_load_dwordx4 v8, s[4:7], s24 offen lds
    s_add_u32 m0, s27, 16384
    s_nop 0
    buffer_load_dwordx4 v9, s[8:11], s25 offen lds
    s_add_u32 m0, s27, 20480
    s_nop 0
    buffer_load_dwordx4 v10, s[8:11], s25 offen lds
    s_add_u32 m0, s27, 24576
    s_nop 0
    buffer_load_dwordx4 v11, s[8:11], s25 offen lds
    s_add_u32 m0, s27, 28672
    s_nop 0
    buffer_load_dwordx4 v12, s[8:11], s25 offen lds
    s_add_u32 s24, s24, 128
    s_add_u32 s25, s25, 128
    s_add_u32 m0, s27, 32768
    s_nop 0
    buffer_load_dwordx4 v5, s[4:7], s24 offen lds
    s_add_u32 m0, s27, 36864
    s_nop 0
    buffer_load_dwordx4 v6, s[4:7], s24 offen lds
    s_add_u32 m0, s27, 40960
    s_nop 0
    buffer_load_dwordx4 v7, s[4:7], s24 offen lds
    s_add_u32 m0, s27, 45056
    s_nop 0
    buffer_load_dwordx4 v8, s[4:7], s24 offen lds
    s_add_u32 m0, s27, 49152
    s_nop 0
    buffer_load_dwordx4 v9, s[8:11], s25 offen lds
    s_add_u32 m0, s27, 53248
    s_nop 0
    buffer_load_dwordx4 v10, s[8:11], s25 offen lds
    s_add_u32 m0, s27, 57344
    s_nop 0
    buffer_load_dwordx4 v11, s[8:11], s25 offen lds
    s_add_u32 m0, s27, 61440
    s_nop 0
    buffer_load_dwordx4 v12, s[8:11], s25 offen lds
    s_add_u32 s24, s24, 128
    s_add_u32 s25, s25, 128
    s_add_u32 m0, s27, 65536
    s_nop 0
    buffer_load_dwordx4 v5, s[4:7], s24 offen lds
    s_add_u32 m0, s27, 69632
    s_nop 0
    buffer_load_dwordx4 v6, s[4:7], s24 offen lds
    s_add_u32 m0, s27, 73728
    s_nop 0
    buffer_load_dwordx4 v7, s[4:7], s24 offen lds
    s_add_u32 m0, s27, 77824
    s_nop 0
    buffer_load_dwordx4 v8, s[4:7], s24 offen lds
    s_add_u32 m0, s27, 81920
    s_nop 0
    buffer_load_dwordx4 v9, s[8:11], s25 offen lds
    s_add_u32 m0, s27, 86016
    s_nop 0
    buffer_load_dwordx4 v10, s[8:11], s25 offen lds
    s_add_u32 m0, s27, 90112
    s_nop 0
    buffer_load_dwordx4 v11, s[8:11], s25 offen lds
    s_add_u32 m0, s27, 94208
    s_nop 0
    buffer_load_dwordx4 v12, s[8:11], s25 offen lds
    s_add_u32 s24, s24, 128
    s_add_u32 s25, s25, 128
    s_mov_b32 s16, s50
    s_mov_b32 s17, s51
    s_mov_b32 s18, 3584
    s_mov_b32 s19, 0x00020000
    v_lshrrev_b32 v128, 5, v1
    v_lshlrev_b32 v128, 3, v128
    s_mul_i32 s30, s62, 64
    s_add_u32 s30, s30, s28
    s_lshl_b32 s35, s30, 1
    buffer_load_dwordx2 v[130:131], v128, s[16:19], s35 offen offset:0
    buffer_load_dwordx2 v[132:133], v128, s[16:19], s35 offen offset:16
    buffer_load_dwordx2 v[134:135], v128, s[16:19], s35 offen offset:32
    buffer_load_dwordx2 v[136:137], v128, s[16:19], s35 offen offset:48
    buffer_load_dwordx2 v[138:139], v128, s[16:19], s35 offen offset:64
    buffer_load_dwordx2 v[140:141], v128, s[16:19], s35 offen offset:80
    buffer_load_dwordx2 v[142:143], v128, s[16:19], s35 offen offset:96
    buffer_load_dwordx2 v[144:145], v128, s[16:19], s35 offen offset:112
    s_waitcnt vmcnt(24)
    s_barrier
    ds_read_b128 v[32:35], v13 offset:0
    ds_read_b128 v[36:39], v13 offset:4096
    ds_read_b128 v[48:51], v21 offset:0
    ds_read_b128 v[52:55], v21 offset:4096
    ds_read_b128 v[40:43], v14 offset:0
    ds_read_b128 v[44:47], v14 offset:4096
    ds_read_b128 v[56:59], v22 offset:0
    ds_read_b128 v[60:63], v22 offset:4096
    s_waitcnt lgkmcnt(4)
    v_mfma_f32_32x32x16_bf16 v[64:79], v[32:35], v[48:51], 0
    v_mfma_f32_32x32x16_bf16 v[80:95], v[32:35], v[52:55], 0
    v_mfma_f32_32x32x16_bf16 v[96:111], v[36:39], v[48:51], 0
    v_mfma_f32_32x32x16_bf16 v[112:127], v[36:39], v[52:55], 0
    ds_read_b128 v[32:35], v15 offset:0
    ds_read_b128 v[36:39], v15 offset:4096
    ds_read_b128 v[48:51], v23 offset:0
    ds_read_b128 v[52:55], v23 offset:4096
    s_waitcnt lgkmcnt(4)
    v_mfma_f32_32x32x16_bf16 v[64:79], v[40:43], v[56:59], v[64:79]
    v_mfma_f32_32x32x16_bf16 v[80:95], v[40:43], v[60:63], v[80:95]
    v_mfma_f32_32x32x16_bf16 v[96:111], v[44:47], v[56:59], v[96:111]
    v_mfma_f32_32x32x16_bf16 v[112:127], v[44:47], v[60:63], v[112:127]
    ds_read_b128 v[40:43], v16 offset:0
    ds_read_b128 v[44:47], v16 offset:4096
    ds_read_b128 v[56:59], v24 offset:0
    ds_read_b128 v[60:63], v24 offset:4096
    s_waitcnt lgkmcnt(4)
    v_mfma_f32_32x32x16_bf16 v[64:79], v[32:35], v[48:51], v[64:79]
    v_mfma_f32_32x32x16_bf16 v[80:95], v[32:35], v[52:55], v[80:95]
    v_mfma_f32_32x32x16_bf16 v[96:111], v[36:39], v[48:51], v[96:111]
    v_mfma_f32_32x32x16_bf16 v[112:127], v[36:39], v[52:55], v[112:127]
    s_waitcnt vmcnt(16)
    s_barrier
    ds_read_b128 v[32:35], v13 offset:32768
    ds_read_b128 v[36:39], v13 offset:36864
    ds_read_b128 v[48:51], v21 offset:32768
    ds_read_b128 v[52:55], v21 offset:36864
    s_waitcnt lgkmcnt(4)
    s_add_u32 m0, s27, 98304
    v_mfma_f32_32x32x16_bf16 v[64:79], v[40:43], v[56:59], v[64:79]
    buffer_load_dwordx4 v5, s[4:7], s24 offen lds
    s_add_u32 m0, s27, 102400
    s_nop 0
    buffer_load_dwordx4 v6, s[4:7], s24 offen lds
    s_add_u32 m0, s27, 106496
    v_mfma_f32_32x32x16_bf16 v[80:95], v[40:43], v[60:63], v[80:95]
    buffer_load_dwordx4 v7, s[4:7], s24 offen lds
    s_add_u32 m0, s27, 110592
    s_nop 0
    buffer_load_dwordx4 v8, s[4:7], s24 offen lds
    s_add_u32 m0, s27, 114688
    v_mfma_f32_32x32x16_bf16 v[96:111], v[44:47], v[56:59], v[96:111]
    buffer_load_dwordx4 v9, s[8:11], s25 offen lds
    s_add_u32 m0, s27, 118784
    s_nop 0
    buffer_load_dwordx4 v10, s[8:11], s25 offen lds
    s_add_u32 m0, s27, 122880
    v_mfma_f32_32x32x16_bf16 v[112:127], v[44:47], v[60:63], v[112:127]
    buffer_load_dwordx4 v11, s[8:11], s25 offen lds
    s_add_u32 m0, s27, 126976
    s_nop 0
    buffer_load_dwordx4 v12, s[8:11], s25 offen lds
    s_add_u32 s24, s24, 128
    s_add_u32 s25, s25, 128
    ds_read_b128 v[40:43], v14 offset:32768
    ds_read_b128 v[44:47], v14 offset:36864
    ds_read_b128 v[56:59], v22 offset:32768
    ds_read_b128 v[60:63], v22 offset:36864
    s_waitcnt lgkmcnt(4)
    v_mfma_f32_32x32x16_bf16 v[64:79], v[32:35], v[48:51], v[64:79]
    v_mfma_f32_32x32x16_bf16 v[80:95], v[32:35], v[52:55], v[80:95]
    v_mfma_f32_32x32x16_bf16 v[96:111], v[36:39], v[48:51], v[96:111]
    v_mfma_f32_32x32x16_bf16 v[112:127], v[36:39], v[52:55], v[112:127]
    ds_read_b128 v[32:35], v15 offset:32768
    ds_read_b128 v[36:39], v15 offset:36864
    ds_read_b128 v[48:51], v23 offset:32768
    ds_read_b128 v[52:55], v23 offset:36864
    s_waitcnt lgkmcnt(4)
    v_mfma_f32_32x32x16_bf16 v[64:79], v[40:43], v[56:59], v[64:79]
    v_mfma_f32_32x32x16_bf16 v[80:95], v[40:43], v[60:63], v[80:95]
    v_mfma_f32_32x32x16_bf16 v[96:111], v[44:47], v[56:59], v[96:111]
    v_mfma_f32_32x32x16_bf16 v[112:127], v[44:47], v[60:63], v[112:127]
    ds_read_b128 v[40:43], v16 offset:32768
    ds_read_b128 v[44:47], v16 offset:36864
    ds_read_b128 v[56:59], v24 offset:32768
    ds_read_b128 v[60:63], v24 offset:36864
    s_waitcnt lgkmcnt(4)
    v_mfma_f32_32x32x16_bf16 v[64:79], v[32:35], v[48:51], v[64:79]
    v_mfma_f32_32x32x16_bf16 v[80:95], v[32:35], v[52:55], v[80:95]
    v_mfma_f32_32x32x16_bf16 v[96:111], v[36:39], v[48:51], v[96:111]
    v_mfma_f32_32x32x16_bf16 v[112:127], v[36:39], v[52:55], v[112:127]
    s_waitcnt vmcnt(16)
    s_barrier
    ds_read_b128 v[32:35], v17 offset:0
    ds_read_b128 v[36:39], v17 offset:4096
    ds_read_b128 v[48:51], v25 offset:0
    ds_read_b128 v[52:55], v25 offset:4096
    s_waitcnt lgkmcnt(4)
    s_mov_b32 m0, s27
    v_mfma_f32_32x32x16_bf16 v[64:79], v[40:43], v[56:59], v[64:79]
    buffer_load_dwordx4 v5, s[4:7], s24 offen lds
    s_add_u32 m0, s27, 4096
    s_nop 0
    buffer_load_dwordx4 v6, s[4:7], s24 offen lds
    s_add_u32 m0, s27, 8192
    v_mfma_f32_32x32x16_bf16 v[80:95], v[40:43], v[60:63], v[80:95]
    buffer_load_dwordx4 v7, s[4:7], s24 offen lds
    s_add_u32 m0, s27, 12288
    s_nop 0
    buffer_load_dwordx4 v8, s[4:7], s24 offen lds
    s_add_u32 m0, s27, 16384
    v_mfma_f32_32x32x16_bf16 v[96:111], v[44:47], v[56:59], v[96:111]
    buffer_load_dwordx4 v9, s[8:11], s25 offen lds
    s_add_u32 m0, s27, 20480
    s_nop 0
    buffer_load_dwordx4 v10, s[8:11], s25 offen lds
    s_add_u32 m0, s27, 24576
    v_mfma_f32_32x32x16_bf16 v[112:127], v[44:47], v[60:63], v[112:127]
    buffer_load_dwordx4 v11, s[8:11], s25 offen lds
    s_add_u32 m0, s27, 28672
    s_nop 0
    buffer_load_dwordx4 v12, s[8:11], s25 offen lds
    s_add_u32 s24, s24, 128
    s_add_u32 s25, s25, 128
    s_waitcnt vmcnt(16)
    v_lshlrev_b32 v146, 16, v130
    v_and_b32 v147, 0xffff0000, v130
    v_lshlrev_b32 v148, 16, v131
    v_and_b32 v149, 0xffff0000, v131
    v_lshlrev_b32 v150, 16, v132
    v_and_b32 v151, 0xffff0000, v132
    v_lshlrev_b32 v152, 16, v133
    v_and_b32 v153, 0xffff0000, v133
    v_lshlrev_b32 v154, 16, v134
    v_and_b32 v155, 0xffff0000, v134
    v_lshlrev_b32 v156, 16, v135
    v_and_b32 v157, 0xffff0000, v135
    v_lshlrev_b32 v158, 16, v136
    v_and_b32 v159, 0xffff0000, v136
    v_lshlrev_b32 v160, 16, v137
    v_and_b32 v161, 0xffff0000, v137
    v_lshlrev_b32 v162, 16, v138
    v_and_b32 v163, 0xffff0000, v138
    v_lshlrev_b32 v164, 16, v139
    v_and_b32 v165, 0xffff0000, v139
    v_lshlrev_b32 v166, 16, v140
    v_and_b32 v167, 0xffff0000, v140
    v_lshlrev_b32 v168, 16, v141
    v_and_b32 v169, 0xffff0000, v141
    v_lshlrev_b32 v170, 16, v142
    v_and_b32 v171, 0xffff0000, v142
    v_lshlrev_b32 v172, 16, v143
    v_and_b32 v173, 0xffff0000, v143
    v_lshlrev_b32 v174, 16, v144
    v_and_b32 v175, 0xffff0000, v144
    v_lshlrev_b32 v176, 16, v145
    v_and_b32 v177, 0xffff0000, v145
    ds_read_b128 v[40:43], v18 offset:0
    ds_read_b128 v[44:47], v18 offset:4096
    ds_read_b128 v[56:59], v26 offset:0
    ds_read_b128 v[60:63], v26 offset:4096
    s_waitcnt lgkmcnt(4)
    v_mfma_f32_32x32x16_bf16 v[64:79], v[32:35], v[48:51], v[64:79]
    v_mfma_f32_32x32x16_bf16 v[80:95], v[32:35], v[52:55], v[80:95]
    v_mfma_f32_32x32x16_bf16 v[96:111], v[36:39], v[48:51], v[96:111]
    v_mfma_f32_32x32x16_bf16 v[112:127], v[36:39], v[52:55], v[112:127]
    ds_read_b128 v[32:35], v19 offset:0
    ds_read_b128 v[36:39], v19 offset:4096
    ds_read_b128 v[48:51], v27 offset:0
    ds_read_b128 v[52:55], v27 offset:4096
    s_waitcnt lgkmcnt(4)
    v_mfma_f32_32x32x16_bf16 v[64:79], v[40:43], v[56:59], v[64:79]
    v_mfma_f32_32x32x16_bf16 v[80:95], v[40:43], v[60:63], v[80:95]
    v_mfma_f32_32x32x16_bf16 v[96:111], v[44:47], v[56:59], v[96:111]
    v_mfma_f32_32x32x16_bf16 v[112:127], v[44:47], v[60:63], v[112:127]
    ds_read_b128 v[40:43], v20 offset:0
    ds_read_b128 v[44:47], v20 offset:4096
    ds_read_b128 v[56:59], v28 offset:0
    ds_read_b128 v[60:63], v28 offset:4096
    s_waitcnt lgkmcnt(4)
    v_mfma_f32_32x32x16_bf16 v[64:79], v[32:35], v[48:51], v[64:79]
    v_mfma_f32_32x32x16_bf16 v[80:95], v[32:35], v[52:55], v[80:95]
    v_mfma_f32_32x32x16_bf16 v[96:111], v[36:39], v[48:51], v[96:111]
    v_mfma_f32_32x32x16_bf16 v[112:127], v[36:39], v[52:55], v[112:127]
    s_waitcnt vmcnt(8)
    s_barrier
    ds_read_b128 v[32:35], v17 offset:32768
    ds_read_b128 v[36:39], v17 offset:36864
    ds_read_b128 v[48:51], v25 offset:32768
    ds_read_b128 v[52:55], v25 offset:36864
    s_waitcnt lgkmcnt(4)
    s_add_u32 m0, s27, 32768
    v_mfma_f32_32x32x16_bf16 v[64:79], v[40:43], v[56:59], v[64:79]
    buffer_load_dwordx4 v5, s[4:7], s24 offen lds
    s_add_u32 m0, s27, 36864
    s_nop 0
    buffer_load_dwordx4 v6, s[4:7], s24 offen lds
    s_add_u32 m0, s27, 40960
    v_mfma_f32_32x32x16_bf16 v[80:95], v[40:43], v[60:63], v[80:95]
    buffer_load_dwordx4 v7, s[4:7], s24 offen lds
    s_add_u32 m0, s27, 45056
    s_nop 0
    buffer_load_dwordx4 v8, s[4:7], s24 offen lds
    s_add_u32 m0, s27, 49152
    v_mfma_f32_32x32x16_bf16 v[96:111], v[44:47], v[56:59], v[96:111]
    buffer_load_dwordx4 v9, s[8:11], s25 offen lds
    s_add_u32 m0, s27, 53248
    s_nop 0
    buffer_load_dwordx4 v10, s[8:11], s25 offen lds
    s_add_u32 m0, s27, 57344
    v_mfma_f32_32x32x16_bf16 v[112:127], v[44:47], v[60:63], v[112:127]
    buffer_load_dwordx4 v11, s[8:11], s25 offen lds
    s_add_u32 m0, s27, 61440
    s_nop 0
    buffer_load_dwordx4 v12, s[8:11], s25 offen lds
    s_add_u32 s24, s24, 128
    s_add_u32 s25, s25, 128
    ds_read_b128 v[40:43], v18 offset:32768
    ds_read_b128 v[44:47], v18 offset:36864
    ds_read_b128 v[56:59], v26 offset:32768
    ds_read_b128 v[60:63], v26 offset:36864
    s_waitcnt lgkmcnt(4)
    v_mfma_f32_32x32x16_bf16 v[64:79], v[32:35], v[48:51], v[64:79]
    v_mfma_f32_32x32x16_bf16 v[80:95], v[32:35], v[52:55], v[80:95]
    v_mfma_f32_32x32x16_bf16 v[96:111], v[36:39], v[48:51], v[96:111]
    v_mfma_f32_32x32x16_bf16 v[112:127], v[36:39], v[52:55], v[112:127]
    ds_read_b128 v[32:35], v19 offset:32768
    ds_read_b128 v[36:39], v19 offset:36864
    ds_read_b128 v[48:51], v27 offset:32768
    ds_read_b128 v[52:55], v27 offset:36864
    s_waitcnt lgkmcnt(4)
    v_mfma_f32_32x32x16_bf16 v[64:79], v[40:43], v[56:59], v[64:79]
    v_mfma_f32_32x32x16_bf16 v[80:95], v[40:43], v[60:63], v[80:95]
    v_mfma_f32_32x32x16_bf16 v[96:111], v[44:47], v[56:59], v[96:111]
    v_mfma_f32_32x32x16_bf16 v[112:127], v[44:47], v[60:63], v[112:127]
    ds_read_b128 v[40:43], v20 offset:32768
    ds_read_b128 v[44:47], v20 offset:36864
    ds_read_b128 v[56:59], v28 offset:32768
    ds_read_b128 v[60:63], v28 offset:36864
    s_waitcnt lgkmcnt(4)
    v_mfma_f32_32x32x16_bf16 v[64:79], v[32:35], v[48:51], v[64:79]
    v_mfma_f32_32x32x16_bf16 v[80:95], v[32:35], v[52:55], v[80:95]
    v_mfma_f32_32x32x16_bf16 v[96:111], v[36:39], v[48:51], v[96:111]
    v_mfma_f32_32x32x16_bf16 v[112:127], v[36:39], v[52:55], v[112:127]
    s_waitcnt vmcnt(8)
    s_barrier
    ds_read_b128 v[32:35], v13 offset:0
    ds_read_b128 v[36:39], v13 offset:4096
    ds_read_b128 v[48:51], v21 offset:0
    ds_read_b128 v[52:55], v21 offset:4096
    s_waitcnt lgkmcnt(4)
    s_add_u32 m0, s27, 65536
    v_mfma_f32_32x32x16_bf16 v[64:79], v[40:43], v[56:59], v[64:79]
    buffer_load_dwordx4 v5, s[4:7], s24 offen lds
    s_add_u32 m0, s27, 69632
    s_nop 0
    buffer_load_dwordx4 v6, s[4:7], s24 offen lds
    s_add_u32 m0, s27, 73728
    v_mfma_f32_32x32x16_bf16 v[80:95], v[40:43], v[60:63], v[80:95]
    buffer_load_dwordx4 v7, s[4:7], s24 offen lds
    s_add_u32 m0, s27, 77824
    s_nop 0
    buffer_load_dwordx4 v8, s[4:7], s24 offen lds
    s_add_u32 m0, s27, 81920
    v_mfma_f32_32x32x16_bf16 v[96:111], v[44:47], v[56:59], v[96:111]
    buffer_load_dwordx4 v9, s[8:11], s25 offen lds
    s_add_u32 m0, s27, 86016
    s_nop 0
    buffer_load_dwordx4 v10, s[8:11], s25 offen lds
    s_add_u32 m0, s27, 90112
    v_mfma_f32_32x32x16_bf16 v[112:127], v[44:47], v[60:63], v[112:127]
    buffer_load_dwordx4 v11, s[8:11], s25 offen lds
    s_add_u32 m0, s27, 94208
    s_nop 0
    buffer_load_dwordx4 v12, s[8:11], s25 offen lds
    s_add_u32 s24, s24, 128
    s_add_u32 s25, s25, 128
    ds_read_b128 v[40:43], v14 offset:0
    ds_read_b128 v[44:47], v14 offset:4096
    ds_read_b128 v[56:59], v22 offset:0
    ds_read_b128 v[60:63], v22 offset:4096
    s_waitcnt lgkmcnt(4)
    v_mfma_f32_32x32x16_bf16 v[64:79], v[32:35], v[48:51], v[64:79]
    v_mfma_f32_32x32x16_bf16 v[80:95], v[32:35], v[52:55], v[80:95]
    v_mfma_f32_32x32x16_bf16 v[96:111], v[36:39], v[48:51], v[96:111]
    v_mfma_f32_32x32x16_bf16 v[112:127], v[36:39], v[52:55], v[112:127]
    ds_read_b128 v[32:35], v15 offset:0
    ds_read_b128 v[36:39], v15 offset:4096
    ds_read_b128 v[48:51], v23 offset:0
    ds_read_b128 v[52:55], v23 offset:4096
    s_waitcnt lgkmcnt(4)
    v_mfma_f32_32x32x16_bf16 v[64:79], v[40:43], v[56:59], v[64:79]
    v_mfma_f32_32x32x16_bf16 v[80:95], v[40:43], v[60:63], v[80:95]
    v_mfma_f32_32x32x16_bf16 v[96:111], v[44:47], v[56:59], v[96:111]
    v_mfma_f32_32x32x16_bf16 v[112:127], v[44:47], v[60:63], v[112:127]
    ds_read_b128 v[40:43], v16 offset:0
    ds_read_b128 v[44:47], v16 offset:4096
    ds_read_b128 v[56:59], v24 offset:0
    ds_read_b128 v[60:63], v24 offset:4096
    s_waitcnt lgkmcnt(4)
    v_mfma_f32_32x32x16_bf16 v[64:79], v[32:35], v[48:51], v[64:79]
    v_mfma_f32_32x32x16_bf16 v[80:95], v[32:35], v[52:55], v[80:95]
    v_mfma_f32_32x32x16_bf16 v[96:111], v[36:39], v[48:51], v[96:111]
    v_mfma_f32_32x32x16_bf16 v[112:127], v[36:39], v[52:55], v[112:127]
    s_waitcnt vmcnt(8)
    s_barrier
    ds_read_b128 v[32:35], v13 offset:32768
    ds_read_b128 v[36:39], v13 offset:36864
    ds_read_b128 v[48:51], v21 offset:32768
    ds_read_b128 v[52:55], v21 offset:36864
    s_waitcnt lgkmcnt(4)
    s_add_u32 m0, s27, 98304
    v_mfma_f32_32x32x16_bf16 v[64:79], v[40:43], v[56:59], v[64:79]
    buffer_load_dwordx4 v5, s[4:7], s24 offen lds
    s_add_u32 m0, s27, 102400
    s_nop 0
    buffer_load_dwordx4 v6, s[4:7], s24 offen lds
    s_add_u32 m0, s27, 106496
    v_mfma_f32_32x32x16_bf16 v[80:95], v[40:43], v[60:63], v[80:95]
    buffer_load_dwordx4 v7, s[4:7], s24 offen lds
    s_add_u32 m0, s27, 110592
    s_nop 0
    buffer_load_dwordx4 v8, s[4:7], s24 offen lds
    s_add_u32 m0, s27, 114688
    v_mfma_f32_32x32x16_bf16 v[96:111], v[44:47], v[56:59], v[96:111]
    buffer_load_dwordx4 v9, s[8:11], s25 offen lds
    s_add_u32 m0, s27, 118784
    s_nop 0
    buffer_load_dwordx4 v10, s[8:11], s25 offen lds
    s_add_u32 m0, s27, 122880
    v_mfma_f32_32x32x16_bf16 v[112:127], v[44:47], v[60:63], v[112:127]
    buffer_load_dwordx4 v11, s[8:11], s25 offen lds
    s_add_u32 m0, s27, 126976
    s_nop 0
    buffer_load_dwordx4 v12, s[8:11], s25 offen lds
    s_add_u32 s24, s24, 128
    s_add_u32 s25, s25, 128
    ds_read_b128 v[40:43], v14 offset:32768
    ds_read_b128 v[44:47], v14 offset:36864
    ds_read_b128 v[56:59], v22 offset:32768
    ds_read_b128 v[60:63], v22 offset:36864
    s_waitcnt lgkmcnt(4)
    v_mfma_f32_32x32x16_bf16 v[64:79], v[32:35], v[48:51], v[64:79]
    v_mfma_f32_32x32x16_bf16 v[80:95], v[32:35], v[52:55], v[80:95]
    v_mfma_f32_32x32x16_bf16 v[96:111], v[36:39], v[48:51], v[96:111]
    v_mfma_f32_32x32x16_bf16 v[112:127], v[36:39], v[52:55], v[112:127]
    ds_read_b128 v[32:35], v15 offset:32768
    ds_read_b128 v[36:39], v15 offset:36864
    ds_read_b128 v[48:51], v23 offset:32768
    ds_read_b128 v[52:55], v23 offset:36864
    s_waitcnt lgkmcnt(4)
    v_mfma_f32_32x32x16_bf16 v[64:79], v[40:43], v[56:59], v[64:79]
    v_mfma_f32_32x32x16_bf16 v[80:95], v[40:43], v[60:63], v[80:95]
    v_mfma_f32_32x32x16_bf16 v[96:111], v[44:47], v[56:59], v[96:111]
    v_mfma_f32_32x32x16_bf16 v[112:127], v[44:47], v[60:63], v[112:127]
    ds_read_b128 v[40:43], v16 offset:32768
    ds_read_b128 v[44:47], v16 offset:36864
    ds_read_b128 v[56:59], v24 offset:32768
    ds_read_b128 v[60:63], v24 offset:36864
    s_waitcnt lgkmcnt(4)
    v_mfma_f32_32x32x16_bf16 v[64:79], v[32:35], v[48:51], v[64:79]
    v_mfma_f32_32x32x16_bf16 v[80:95], v[32:35], v[52:55], v[80:95]
    v_mfma_f32_32x32x16_bf16 v[96:111], v[36:39], v[48:51], v[96:111]
    v_mfma_f32_32x32x16_bf16 v[112:127], v[36:39], v[52:55], v[112:127]
    s_waitcnt vmcnt(8)
    s_barrier
    ds_read_b128 v[32:35], v17 offset:0
    ds_read_b128 v[36:39], v17 offset:4096
    ds_read_b128 v[48:51], v25 offset:0
    ds_read_b128 v[52:55], v25 offset:4096
    s_waitcnt lgkmcnt(4)
    v_mfma_f32_32x32x16_bf16 v[64:79], v[40:43], v[56:59], v[64:79]
    v_mfma_f32_32x32x16_bf16 v[80:95], v[40:43], v[60:63], v[80:95]
    v_mfma_f32_32x32x16_bf16 v[96:111], v[44:47], v[56:59], v[96:111]
    v_mfma_f32_32x32x16_bf16 v[112:127], v[44:47], v[60:63], v[112:127]
    ds_read_b128 v[40:43], v18 offset:0
    ds_read_b128 v[44:47], v18 offset:4096
    ds_read_b128 v[56:59], v26 offset:0
    ds_read_b128 v[60:63], v26 offset:4096
    s_waitcnt lgkmcnt(4)
    v_mfma_f32_32x32x16_bf16 v[64:79], v[32:35], v[48:51], v[64:79]
    v_mfma_f32_32x32x16_bf16 v[80:95], v[32:35], v[52:55], v[80:95]
    v_mfma_f32_32x32x16_bf16 v[96:111], v[36:39], v[48:51], v[96:111]
    v_mfma_f32_32x32x16_bf16 v[112:127], v[36:39], v[52:55], v[112:127]
    ds_read_b128 v[32:35], v19 offset:0
    ds_read_b128 v[36:39], v19 offset:4096
    ds_read_b128 v[48:51], v27 offset:0
    ds_read_b128 v[52:55], v27 offset:4096
    s_waitcnt lgkmcnt(4)
    v_mfma_f32_32x32x16_bf16 v[64:79], v[40:43], v[56:59], v[64:79]
    v_mfma_f32_32x32x16_bf16 v[80:95], v[40:43], v[60:63], v[80:95]
    v_mfma_f32_32x32x16_bf16 v[96:111], v[44:47], v[56:59], v[96:111]
    v_mfma_f32_32x32x16_bf16 v[112:127], v[44:47], v[60:63], v[112:127]
    ds_read_b128 v[40:43], v20 offset:0
    ds_read_b128 v[44:47], v20 offset:4096
    ds_read_b128 v[56:59], v28 offset:0
    ds_read_b128 v[60:63], v28 offset:4096
    s_waitcnt lgkmcnt(4)
    v_mfma_f32_32x32x16_bf16 v[64:79], v[32:35], v[48:51], v[64:79]
    v_mfma_f32_32x32x16_bf16 v[80:95], v[32:35], v[52:55], v[80:95]
    v_mfma_f32_32x32x16_bf16 v[96:111], v[36:39], v[48:51], v[96:111]
    v_mfma_f32_32x32x16_bf16 v[112:127], v[36:39], v[52:55], v[112:127]
    s_waitcnt vmcnt(0)
    s_barrier
    ds_read_b128 v[32:35], v17 offset:32768
    ds_read_b128 v[36:39], v17 offset:36864
    ds_read_b128 v[48:51], v25 offset:32768
    ds_read_b128 v[52:55], v25 offset:36864
    s_waitcnt lgkmcnt(4)
    v_mfma_f32_32x32x16_bf16 v[64:79], v[40:43], v[56:59], v[64:79]
    v_mfma_f32_32x32x16_bf16 v[80:95], v[40:43], v[60:63], v[80:95]
    v_mfma_f32_32x32x16_bf16 v[96:111], v[44:47], v[56:59], v[96:111]
    v_mfma_f32_32x32x16_bf16 v[112:127], v[44:47], v[60:63], v[112:127]
    ds_read_b128 v[40:43], v18 offset:32768
    ds_read_b128 v[44:47], v18 offset:36864
    ds_read_b128 v[56:59], v26 offset:32768
    ds_read_b128 v[60:63], v26 offset:36864
    s_waitcnt lgkmcnt(4)
    v_mfma_f32_32x32x16_bf16 v[64:79], v[32:35], v[48:51], v[64:79]
    v_mfma_f32_32x32x16_bf16 v[80:95], v[32:35], v[52:55], v[80:95]
    v_mfma_f32_32x32x16_bf16 v[96:111], v[36:39], v[48:51], v[96:111]
    v_mfma_f32_32x32x16_bf16 v[112:127], v[36:39], v[52:55], v[112:127]
    ds_read_b128 v[32:35], v19 offset:32768
    ds_read_b128 v[36:39], v19 offset:36864
    ds_read_b128 v[48:51], v27 offset:32768
    ds_read_b128 v[52:55], v27 offset:36864
    s_waitcnt lgkmcnt(4)
    v_mfma_f32_32x32x16_bf16 v[64:79], v[40:43], v[56:59], v[64:79]
    v_mfma_f32_32x32x16_bf16 v[80:95], v[40:43], v[60:63], v[80:95]
    v_mfma_f32_32x32x16_bf16 v[96:111], v[44:47], v[56:59], v[96:111]
    v_mfma_f32_32x32x16_bf16 v[112:127], v[44:47], v[60:63], v[112:127]
    ds_read_b128 v[40:43], v20 offset:32768
    ds_read_b128 v[44:47], v20 offset:36864
    ds_read_b128 v[56:59], v28 offset:32768
    ds_read_b128 v[60:63], v28 offset:36864
    s_waitcnt lgkmcnt(4)
    v_mfma_f32_32x32x16_bf16 v[64:79], v[32:35], v[48:51], v[64:79]
    v_mfma_f32_32x32x16_bf16 v[80:95], v[32:35], v[52:55], v[80:95]
    v_mfma_f32_32x32x16_bf16 v[96:111], v[36:39], v[48:51], v[96:111]
    v_mfma_f32_32x32x16_bf16 v[112:127], v[36:39], v[52:55], v[112:127]
    s_waitcnt lgkmcnt(0)
    v_mfma_f32_32x32x16_bf16 v[64:79], v[40:43], v[56:59], v[64:79]
    v_mfma_f32_32x32x16_bf16 v[80:95], v[40:43], v[60:63], v[80:95]
    v_mfma_f32_32x32x16_bf16 v[96:111], v[44:47], v[56:59], v[96:111]
    v_mfma_f32_32x32x16_bf16 v[112:127], v[44:47], v[60:63], v[112:127]
    s_nop 15
    v_and_b32 v178, 31, v1
    s_mul_i32 s30, s63, 64
    v_add_u32 v178, s30, v178
    s_mov_b32 s30, 3584
    v_mul_lo_u32 v178, v178, s30
    v_lshrrev_b32 v180, 5, v1
    v_lshlrev_b32 v180, 3, v180
    v_add_u32 v179, v178, v180
    v_add_u32 v178, v179, v180
    s_mul_i32 s33, s29, 3584
    s_mul_i32 s30, s62, 64
    s_add_u32 s30, s30, s28
    s_lshl_b32 s30, s30, 1
    s_add_u32 s33, s33, s30
    s_add_u32 s34, s33, 0
    v_cvt_pk_bf16_f32 v192, v64, v65
    v_cvt_pk_bf16_f32 v193, v66, v67
    v_lshlrev_b32 v194, 16, v192
    v_and_b32 v195, 0xffff0000, v192
    v_lshlrev_b32 v196, 16, v193
    v_and_b32 v197, 0xffff0000, v193
    v_pk_add_f32 v[194:195], v[194:195], v[146:147]
    v_pk_add_f32 v[196:197], v[196:197], v[148:149]
    v_cvt_pk_bf16_f32 v192, v194, v195
    v_cvt_pk_bf16_f32 v193, v196, v197
    v_pk_max_i16 v192, v192, 0
    v_pk_max_i16 v193, v193, 0
    v_lshlrev_b32 v194, 16, v192
    v_and_b32 v195, 0xffff0000, v192
    v_lshlrev_b32 v196, 16, v193
    v_and_b32 v197, 0xffff0000, v193
    v_pk_mul_f32 v[194:195], v[194:195], v[194:195]
    v_pk_mul_f32 v[196:197], v[196:197], v[196:197]
    v_cvt_pk_bf16_f32 v184, v194, v195
    v_cvt_pk_bf16_f32 v185, v196, v197
    v_cvt_pk_bf16_f32 v192, v68, v69
    v_cvt_pk_bf16_f32 v193, v70, v71
    v_lshlrev_b32 v194, 16, v192
    v_and_b32 v195, 0xffff0000, v192
    v_lshlrev_b32 v196, 16, v193
    v_and_b32 v197, 0xffff0000, v193
    v_pk_add_f32 v[194:195], v[194:195], v[150:151]
    v_pk_add_f32 v[196:197], v[196:197], v[152:153]
    v_cvt_pk_bf16_f32 v192, v194, v195
    v_cvt_pk_bf16_f32 v193, v196, v197
    v_pk_max_i16 v192, v192, 0
    v_pk_max_i16 v193, v193, 0
    v_lshlrev_b32 v194, 16, v192
    v_and_b32 v195, 0xffff0000, v192
    v_lshlrev_b32 v196, 16, v193
    v_and_b32 v197, 0xffff0000, v193
    v_pk_mul_f32 v[194:195], v[194:195], v[194:195]
    v_pk_mul_f32 v[196:197], v[196:197], v[196:197]
    v_cvt_pk_bf16_f32 v186, v194, v195
    v_cvt_pk_bf16_f32 v187, v196, v197
    s_nop 1
    v_permlane32_swap_b32 v184, v186
    v_permlane32_swap_b32 v185, v187
    buffer_store_dwordx4 v[184:187], v178, s[12:15], s34 offen offset:0
    v_cvt_pk_bf16_f32 v192, v72, v73
    v_cvt_pk_bf16_f32 v193, v74, v75
    v_lshlrev_b32 v194, 16, v192
    v_and_b32 v195, 0xffff0000, v192
    v_lshlrev_b32 v196, 16, v193
    v_and_b32 v197, 0xffff0000, v193
    v_pk_add_f32 v[194:195], v[194:195], v[154:155]
    v_pk_add_f32 v[196:197], v[196:197], v[156:157]
    v_cvt_pk_bf16_f32 v192, v194, v195
    v_cvt_pk_bf16_f32 v193, v196, v197
    v_pk_max_i16 v192, v192, 0
    v_pk_max_i16 v193, v193, 0
    v_lshlrev_b32 v194, 16, v192
    v_and_b32 v195, 0xffff0000, v192
    v_lshlrev_b32 v196, 16, v193
    v_and_b32 v197, 0xffff0000, v193
    v_pk_mul_f32 v[194:195], v[194:195], v[194:195]
    v_pk_mul_f32 v[196:197], v[196:197], v[196:197]
    v_cvt_pk_bf16_f32 v188, v194, v195
    v_cvt_pk_bf16_f32 v189, v196, v197
    v_cvt_pk_bf16_f32 v192, v76, v77
    v_cvt_pk_bf16_f32 v193, v78, v79
    v_lshlrev_b32 v194, 16, v192
    v_and_b32 v195, 0xffff0000, v192
    v_lshlrev_b32 v196, 16, v193
    v_and_b32 v197, 0xffff0000, v193
    v_pk_add_f32 v[194:195], v[194:195], v[158:159]
    v_pk_add_f32 v[196:197], v[196:197], v[160:161]
    v_cvt_pk_bf16_f32 v192, v194, v195
    v_cvt_pk_bf16_f32 v193, v196, v197
    v_pk_max_i16 v192, v192, 0
    v_pk_max_i16 v193, v193, 0
    v_lshlrev_b32 v194, 16, v192
    v_and_b32 v195, 0xffff0000, v192
    v_lshlrev_b32 v196, 16, v193
    v_and_b32 v197, 0xffff0000, v193
    v_pk_mul_f32 v[194:195], v[194:195], v[194:195]
    v_pk_mul_f32 v[196:197], v[196:197], v[196:197]
    v_cvt_pk_bf16_f32 v190, v194, v195
    v_cvt_pk_bf16_f32 v191, v196, v197
    s_nop 1
    v_permlane32_swap_b32 v188, v190
    v_permlane32_swap_b32 v189, v191
    buffer_store_dwordx4 v[188:191], v178, s[12:15], s34 offen offset:32
    v_cvt_pk_bf16_f32 v192, v96, v97
    v_cvt_pk_bf16_f32 v193, v98, v99
    v_lshlrev_b32 v194, 16, v192
    v_and_b32 v195, 0xffff0000, v192
    v_lshlrev_b32 v196, 16, v193
    v_and_b32 v197, 0xffff0000, v193
    v_pk_add_f32 v[194:195], v[194:195], v[162:163]
    v_pk_add_f32 v[196:197], v[196:197], v[164:165]
    v_cvt_pk_bf16_f32 v192, v194, v195
    v_cvt_pk_bf16_f32 v193, v196, v197
    v_pk_max_i16 v192, v192, 0
    v_pk_max_i16 v193, v193, 0
    v_lshlrev_b32 v194, 16, v192
    v_and_b32 v195, 0xffff0000, v192
    v_lshlrev_b32 v196, 16, v193
    v_and_b32 v197, 0xffff0000, v193
    v_pk_mul_f32 v[194:195], v[194:195], v[194:195]
    v_pk_mul_f32 v[196:197], v[196:197], v[196:197]
    v_cvt_pk_bf16_f32 v184, v194, v195
    v_cvt_pk_bf16_f32 v185, v196, v197
    v_cvt_pk_bf16_f32 v192, v100, v101
    v_cvt_pk_bf16_f32 v193, v102, v103
    v_lshlrev_b32 v194, 16, v192
    v_and_b32 v195, 0xffff0000, v192
    v_lshlrev_b32 v196, 16, v193
    v_and_b32 v197, 0xffff0000, v193
    v_pk_add_f32 v[194:195], v[194:195], v[166:167]
    v_pk_add_f32 v[196:197], v[196:197], v[168:169]
    v_cvt_pk_bf16_f32 v192, v194, v195
    v_cvt_pk_bf16_f32 v193, v196, v197
    v_pk_max_i16 v192, v192, 0
    v_pk_max_i16 v193, v193, 0
    v_lshlrev_b32 v194, 16, v192
    v_and_b32 v195, 0xffff0000, v192
    v_lshlrev_b32 v196, 16, v193
    v_and_b32 v197, 0xffff0000, v193
    v_pk_mul_f32 v[194:195], v[194:195], v[194:195]
    v_pk_mul_f32 v[196:197], v[196:197], v[196:197]
    v_cvt_pk_bf16_f32 v186, v194, v195
    v_cvt_pk_bf16_f32 v187, v196, v197
    s_nop 1
    v_permlane32_swap_b32 v184, v186
    v_permlane32_swap_b32 v185, v187
    buffer_store_dwordx4 v[184:187], v178, s[12:15], s34 offen offset:64
    v_cvt_pk_bf16_f32 v192, v104, v105
    v_cvt_pk_bf16_f32 v193, v106, v107
    v_lshlrev_b32 v194, 16, v192
    v_and_b32 v195, 0xffff0000, v192
    v_lshlrev_b32 v196, 16, v193
    v_and_b32 v197, 0xffff0000, v193
    v_pk_add_f32 v[194:195], v[194:195], v[170:171]
    v_pk_add_f32 v[196:197], v[196:197], v[172:173]
    v_cvt_pk_bf16_f32 v192, v194, v195
    v_cvt_pk_bf16_f32 v193, v196, v197
    v_pk_max_i16 v192, v192, 0
    v_pk_max_i16 v193, v193, 0
    v_lshlrev_b32 v194, 16, v192
    v_and_b32 v195, 0xffff0000, v192
    v_lshlrev_b32 v196, 16, v193
    v_and_b32 v197, 0xffff0000, v193
    v_pk_mul_f32 v[194:195], v[194:195], v[194:195]
    v_pk_mul_f32 v[196:197], v[196:197], v[196:197]
    v_cvt_pk_bf16_f32 v188, v194, v195
    v_cvt_pk_bf16_f32 v189, v196, v197
    v_cvt_pk_bf16_f32 v192, v108, v109
    v_cvt_pk_bf16_f32 v193, v110, v111
    v_lshlrev_b32 v194, 16, v192
    v_and_b32 v195, 0xffff0000, v192
    v_lshlrev_b32 v196, 16, v193
    v_and_b32 v197, 0xffff0000, v193
    v_pk_add_f32 v[194:195], v[194:195], v[174:175]
    v_pk_add_f32 v[196:197], v[196:197], v[176:177]
    v_cvt_pk_bf16_f32 v192, v194, v195
    v_cvt_pk_bf16_f32 v193, v196, v197
    v_pk_max_i16 v192, v192, 0
    v_pk_max_i16 v193, v193, 0
    v_lshlrev_b32 v194, 16, v192
    v_and_b32 v195, 0xffff0000, v192
    v_lshlrev_b32 v196, 16, v193
    v_and_b32 v197, 0xffff0000, v193
    v_pk_mul_f32 v[194:195], v[194:195], v[194:195]
    v_pk_mul_f32 v[196:197], v[196:197], v[196:197]
    v_cvt_pk_bf16_f32 v190, v194, v195
    v_cvt_pk_bf16_f32 v191, v196, v197
    s_nop 1
    v_permlane32_swap_b32 v188, v190
    v_permlane32_swap_b32 v189, v191
    buffer_store_dwordx4 v[188:191], v178, s[12:15], s34 offen offset:96
    s_add_u32 s34, s33, 114688
    v_cvt_pk_bf16_f32 v192, v80, v81
    v_cvt_pk_bf16_f32 v193, v82, v83
    v_lshlrev_b32 v194, 16, v192
    v_and_b32 v195, 0xffff0000, v192
    v_lshlrev_b32 v196, 16, v193
    v_and_b32 v197, 0xffff0000, v193
    v_pk_add_f32 v[194:195], v[194:195], v[146:147]
    v_pk_add_f32 v[196:197], v[196:197], v[148:149]
    v_cvt_pk_bf16_f32 v192, v194, v195
    v_cvt_pk_bf16_f32 v193, v196, v197
    v_pk_max_i16 v192, v192, 0
    v_pk_max_i16 v193, v193, 0
    v_lshlrev_b32 v194, 16, v192
    v_and_b32 v195, 0xffff0000, v192
    v_lshlrev_b32 v196, 16, v193
    v_and_b32 v197, 0xffff0000, v193
    v_pk_mul_f32 v[194:195], v[194:195], v[194:195]
    v_pk_mul_f32 v[196:197], v[196:197], v[196:197]
    v_cvt_pk_bf16_f32 v184, v194, v195
    v_cvt_pk_bf16_f32 v185, v196, v197
    v_cvt_pk_bf16_f32 v192, v84, v85
    v_cvt_pk_bf16_f32 v193, v86, v87
    v_lshlrev_b32 v194, 16, v192
    v_and_b32 v195, 0xffff0000, v192
    v_lshlrev_b32 v196, 16, v193
    v_and_b32 v197, 0xffff0000, v193
    v_pk_add_f32 v[194:195], v[194:195], v[150:151]
    v_pk_add_f32 v[196:197], v[196:197], v[152:153]
    v_cvt_pk_bf16_f32 v192, v194, v195
    v_cvt_pk_bf16_f32 v193, v196, v197
    v_pk_max_i16 v192, v192, 0
    v_pk_max_i16 v193, v193, 0
    v_lshlrev_b32 v194, 16, v192
    v_and_b32 v195, 0xffff0000, v192
    v_lshlrev_b32 v196, 16, v193
    v_and_b32 v197, 0xffff0000, v193
    v_pk_mul_f32 v[194:195], v[194:195], v[194:195]
    v_pk_mul_f32 v[196:197], v[196:197], v[196:197]
    v_cvt_pk_bf16_f32 v186, v194, v195
    v_cvt_pk_bf16_f32 v187, v196, v197
    s_nop 1
    v_permlane32_swap_b32 v184, v186
    v_permlane32_swap_b32 v185, v187
    buffer_store_dwordx4 v[184:187], v178, s[12:15], s34 offen offset:0
    v_cvt_pk_bf16_f32 v192, v88, v89
    v_cvt_pk_bf16_f32 v193, v90, v91
    v_lshlrev_b32 v194, 16, v192
    v_and_b32 v195, 0xffff0000, v192
    v_lshlrev_b32 v196, 16, v193
    v_and_b32 v197, 0xffff0000, v193
    v_pk_add_f32 v[194:195], v[194:195], v[154:155]
    v_pk_add_f32 v[196:197], v[196:197], v[156:157]
    v_cvt_pk_bf16_f32 v192, v194, v195
    v_cvt_pk_bf16_f32 v193, v196, v197
    v_pk_max_i16 v192, v192, 0
    v_pk_max_i16 v193, v193, 0
    v_lshlrev_b32 v194, 16, v192
    v_and_b32 v195, 0xffff0000, v192
    v_lshlrev_b32 v196, 16, v193
    v_and_b32 v197, 0xffff0000, v193
    v_pk_mul_f32 v[194:195], v[194:195], v[194:195]
    v_pk_mul_f32 v[196:197], v[196:197], v[196:197]
    v_cvt_pk_bf16_f32 v188, v194, v195
    v_cvt_pk_bf16_f32 v189, v196, v197
    v_cvt_pk_bf16_f32 v192, v92, v93
    v_cvt_pk_bf16_f32 v193, v94, v95
    v_lshlrev_b32 v194, 16, v192
    v_and_b32 v195, 0xffff0000, v192
    v_lshlrev_b32 v196, 16, v193
    v_and_b32 v197, 0xffff0000, v193
    v_pk_add_f32 v[194:195], v[194:195], v[158:159]
    v_pk_add_f32 v[196:197], v[196:197], v[160:161]
    v_cvt_pk_bf16_f32 v192, v194, v195
    v_cvt_pk_bf16_f32 v193, v196, v197
    v_pk_max_i16 v192, v192, 0
    v_pk_max_i16 v193, v193, 0
    v_lshlrev_b32 v194, 16, v192
    v_and_b32 v195, 0xffff0000, v192
    v_lshlrev_b32 v196, 16, v193
    v_and_b32 v197, 0xffff0000, v193
    v_pk_mul_f32 v[194:195], v[194:195], v[194:195]
    v_pk_mul_f32 v[196:197], v[196:197], v[196:197]
    v_cvt_pk_bf16_f32 v190, v194, v195
    v_cvt_pk_bf16_f32 v191, v196, v197
    s_nop 1
    v_permlane32_swap_b32 v188, v190
    v_permlane32_swap_b32 v189, v191
    buffer_store_dwordx4 v[188:191], v178, s[12:15], s34 offen offset:32
    v_cvt_pk_bf16_f32 v192, v112, v113
    v_cvt_pk_bf16_f32 v193, v114, v115
    v_lshlrev_b32 v194, 16, v192
    v_and_b32 v195, 0xffff0000, v192
    v_lshlrev_b32 v196, 16, v193
    v_and_b32 v197, 0xffff0000, v193
    v_pk_add_f32 v[194:195], v[194:195], v[162:163]
    v_pk_add_f32 v[196:197], v[196:197], v[164:165]
    v_cvt_pk_bf16_f32 v192, v194, v195
    v_cvt_pk_bf16_f32 v193, v196, v197
    v_pk_max_i16 v192, v192, 0
    v_pk_max_i16 v193, v193, 0
    v_lshlrev_b32 v194, 16, v192
    v_and_b32 v195, 0xffff0000, v192
    v_lshlrev_b32 v196, 16, v193
    v_and_b32 v197, 0xffff0000, v193
    v_pk_mul_f32 v[194:195], v[194:195], v[194:195]
    v_pk_mul_f32 v[196:197], v[196:197], v[196:197]
    v_cvt_pk_bf16_f32 v184, v194, v195
    v_cvt_pk_bf16_f32 v185, v196, v197
    v_cvt_pk_bf16_f32 v192, v116, v117
    v_cvt_pk_bf16_f32 v193, v118, v119
    v_lshlrev_b32 v194, 16, v192
    v_and_b32 v195, 0xffff0000, v192
    v_lshlrev_b32 v196, 16, v193
    v_and_b32 v197, 0xffff0000, v193
    v_pk_add_f32 v[194:195], v[194:195], v[166:167]
    v_pk_add_f32 v[196:197], v[196:197], v[168:169]
    v_cvt_pk_bf16_f32 v192, v194, v195
    v_cvt_pk_bf16_f32 v193, v196, v197
    v_pk_max_i16 v192, v192, 0
    v_pk_max_i16 v193, v193, 0
    v_lshlrev_b32 v194, 16, v192
    v_and_b32 v195, 0xffff0000, v192
    v_lshlrev_b32 v196, 16, v193
    v_and_b32 v197, 0xffff0000, v193
    v_pk_mul_f32 v[194:195], v[194:195], v[194:195]
    v_pk_mul_f32 v[196:197], v[196:197], v[196:197]
    v_cvt_pk_bf16_f32 v186, v194, v195
    v_cvt_pk_bf16_f32 v187, v196, v197
    s_nop 1
    v_permlane32_swap_b32 v184, v186
    v_permlane32_swap_b32 v185, v187
    buffer_store_dwordx4 v[184:187], v178, s[12:15], s34 offen offset:64
    v_cvt_pk_bf16_f32 v192, v120, v121
    v_cvt_pk_bf16_f32 v193, v122, v123
    v_lshlrev_b32 v194, 16, v192
    v_and_b32 v195, 0xffff0000, v192
    v_lshlrev_b32 v196, 16, v193
    v_and_b32 v197, 0xffff0000, v193
    v_pk_add_f32 v[194:195], v[194:195], v[170:171]
    v_pk_add_f32 v[196:197], v[196:197], v[172:173]
    v_cvt_pk_bf16_f32 v192, v194, v195
    v_cvt_pk_bf16_f32 v193, v196, v197
    v_pk_max_i16 v192, v192, 0
    v_pk_max_i16 v193, v193, 0
    v_lshlrev_b32 v194, 16, v192
    v_and_b32 v195, 0xffff0000, v192
    v_lshlrev_b32 v196, 16, v193
    v_and_b32 v197, 0xffff0000, v193
    v_pk_mul_f32 v[194:195], v[194:195], v[194:195]
    v_pk_mul_f32 v[196:197], v[196:197], v[196:197]
    v_cvt_pk_bf16_f32 v188, v194, v195
    v_cvt_pk_bf16_f32 v189, v196, v197
    v_cvt_pk_bf16_f32 v192, v124, v125
    v_cvt_pk_bf16_f32 v193, v126, v127
    v_lshlrev_b32 v194, 16, v192
    v_and_b32 v195, 0xffff0000, v192
    v_lshlrev_b32 v196, 16, v193
    v_and_b32 v197, 0xffff0000, v193
    v_pk_add_f32 v[194:195], v[194:195], v[174:175]
    v_pk_add_f32 v[196:197], v[196:197], v[176:177]
    v_cvt_pk_bf16_f32 v192, v194, v195
    v_cvt_pk_bf16_f32 v193, v196, v197
    v_pk_max_i16 v192, v192, 0
    v_pk_max_i16 v193, v193, 0
    v_lshlrev_b32 v194, 16, v192
    v_and_b32 v195, 0xffff0000, v192
    v_lshlrev_b32 v196, 16, v193
    v_and_b32 v197, 0xffff0000, v193
    v_pk_mul_f32 v[194:195], v[194:195], v[194:195]
    v_pk_mul_f32 v[196:197], v[196:197], v[196:197]
    v_cvt_pk_bf16_f32 v190, v194, v195
    v_cvt_pk_bf16_f32 v191, v196, v197
    s_nop 1
    v_permlane32_swap_b32 v188, v190
    v_permlane32_swap_b32 v189, v191
    buffer_store_dwordx4 v[188:191], v178, s[12:15], s34 offen offset:96
p3_kernel_end:
    s_endpgm
.globl p4_kernel
.p2align 8
.type p4_kernel,@function
p4_kernel:
    s_cmp_ge_u32 s2, 256
    s_cbranch_scc1 p4_kernel_end
    s_load_dwordx16 s[36:51], s[0:1], 0
    s_load_dwordx8 s[52:59], s[0:1], 64
    s_load_dwordx2 s[60:61], s[0:1], 96
    v_and_b32 v1, 63, v0
    v_lshrrev_b32 v2, 6, v0
    s_nop 0
    v_readfirstlane_b32 s26, v2
    s_nop 1
    s_lshl_b32 s27, s26, 10
    s_lshr_b32 s62, s26, 1
    s_and_b32 s63, s26, 1
    s_waitcnt lgkmcnt(0)
    s_and_b32 s30, s2, 7
    s_lshr_b32 s31, s2, 3
    s_lshl_b32 s30, s30, 2
    s_and_b32 s32, s31, 3
    s_add_u32 s30, s30, s32
    s_lshl_b32 s29, s30, 6
    s_lshr_b32 s31, s31, 2
    s_lshl_b32 s28, s31, 6
    s_add_u32 s4, s60, 2097152
    s_addc_u32 s5, s61, 0
    s_mov_b32 s6, 1835008
    s_mov_b32 s7, 0x00020000
    s_add_u32 s8, s60, 14680064
    s_addc_u32 s9, s61, 0
    s_mov_b32 s10, 7340032
    s_mov_b32 s11, 0x00020000
    s_mov_b32 s12, s56
    s_mov_b32 s13, s57
    s_mov_b32 s14, 2097152
    s_mov_b32 s15, 0x00020000
    s_mul_i32 s24, s28, 3584
    s_mul_i32 s25, s29, 3584
    v_lshrrev_b32 v2, 4, v1
    s_and_b32 s30, s26, 1
    s_lshl_b32 s30, s30, 2
    v_add_u32 v2, s30, v2
    v_and_b32 v3, 7, v1
    v_xor_b32 v2, v2, v3
    v_lshlrev_b32 v2, 4, v2
    v_lshrrev_b32 v3, 3, v1
    s_lshl_b32 s30, s26, 3
    v_add_u32 v3, s30, v3
    s_mov_b32 s31, 3584
    s_mov_b32 s32, 3584
    v_add_u32 v4, 0, v3
    v_mul_lo_u32 v5, v4, s31
    v_add_u32 v5, v5, v2
    v_add_u32 v4, 32, v3
    v_mul_lo_u32 v6, v4, s31
    v_add_u32 v6, v6, v2
    v_add_u32 v4, 0, v3
    v_mul_lo_u32 v7, v4, s32
    v_add_u32 v7, v7, v2
    v_add_u32 v4, 32, v3
    v_mul_lo_u32 v8, v4, s32
    v_add_u32 v8, v8, v2
    v_and_b32 v2, 31, v1
    v_lshrrev_b32 v3, 1, v2
    v_and_b32 v3, 7, v3
    v_lshrrev_b32 v4, 5, v1
    v_xor_b32 v3, v3, v4
    v_lshlrev_b32 v3, 4, v3
    v_lshlrev_b32 v2, 7, v2
    v_add_u32 v2, v2, v3
    s_mul_i32 s30, s62, 4096
    s_mul_i32 s31, s63, 4096
    s_add_u32 s31, s31, 8192
    v_xor_b32 v3, 0, v2
    v_add_u32 v9, s30, v3
    v_add_u32 v17, s31, v3
    v_add_u32 v13, 65536, v9
    v_add_u32 v21, 65536, v17
    v_xor_b32 v3, 32, v2
    v_add_u32 v10, s30, v3
    v_add_u32 v18, s31, v3
    v_add_u32 v14, 65536, v10
    v_add_u32 v22, 65536, v18
    v_xor_b32 v3, 64, v2
    v_add_u32 v11, s30, v3
    v_add_u32 v19, s31, v3
    v_add_u32 v15, 65536, v11
    v_add_u32 v23, 65536, v19
    v_xor_b32 v3, 96, v2
    v_add_u32 v12, s30, v3
    v_add_u32 v20, s31, v3
    v_add_u32 v16, 65536, v12
    v_add_u32 v24, 65536, v20
    s_mov_b32 m0, s27
    s_nop 0
    buffer_load_dwordx4 v5, s[4:7], s24 offen lds
    s_add_u32 m0, s27, 4096
    s_nop 0
    buffer_load_dwordx4 v6, s[4:7], s24 offen lds
    s_add_u32 m0, s27, 8192
    s_nop 0
    buffer_load_dwordx4 v7, s[8:11], s25 offen lds
    s_add_u32 m0, s27, 12288
    s_nop 0
    buffer_load_dwordx4 v8, s[8:11], s25 offen lds
    s_add_u32 s24, s24, 128
    s_add_u32 s25, s25, 128
    s_add_u32 m0, s27, 16384
    s_nop 0
    buffer_load_dwordx4 v5, s[4:7], s24 offen lds
    s_add_u32 m0, s27, 20480
    s_nop 0
    buffer_load_dwordx4 v6, s[4:7], s24 offen lds
    s_add_u32 m0, s27, 24576
    s_nop 0
    buffer_load_dwordx4 v7, s[8:11], s25 offen lds
    s_add_u32 m0, s27, 28672
    s_nop 0
    buffer_load_dwordx4 v8, s[8:11], s25 offen lds
    s_add_u32 s24, s24, 128
    s_add_u32 s25, s25, 128
    s_add_u32 m0, s27, 32768
    s_nop 0
    buffer_load_dwordx4 v5, s[4:7], s24 offen lds
    s_add_u32 m0, s27, 36864
    s_nop 0
    buffer_load_dwordx4 v6, s[4:7], s24 offen lds
    s_add_u32 m0, s27, 40960
    s_nop 0
    buffer_load_dwordx4 v7, s[8:11], s25 offen lds
    s_add_u32 m0, s27, 45056
    s_nop 0
    buffer_load_dwordx4 v8, s[8:11], s25 offen lds
    s_add_u32 s24, s24, 128
    s_add_u32 s25, s25, 128
    s_add_u32 m0, s27, 49152
    s_nop 0
    buffer_load_dwordx4 v5, s[4:7], s24 offen lds
    s_add_u32 m0, s27, 53248
    s_nop 0
    buffer_load_dwordx4 v6, s[4:7], s24 offen lds
    s_add_u32 m0, s27, 57344
    s_nop 0
    buffer_load_dwordx4 v7, s[8:11], s25 offen lds
    s_add_u32 m0, s27, 61440
    s_nop 0
    buffer_load_dwordx4 v8, s[8:11], s25 offen lds
    s_add_u32 s24, s24, 128
    s_add_u32 s25, s25, 128
    s_add_u32 m0, s27, 65536
    s_nop 0
    buffer_load_dwordx4 v5, s[4:7], s24 offen lds
    s_add_u32 m0, s27, 69632
    s_nop 0
    buffer_load_dwordx4 v6, s[4:7], s24 offen lds
    s_add_u32 m0, s27, 73728
    s_nop 0
    buffer_load_dwordx4 v7, s[8:11], s25 offen lds
    s_add_u32 m0, s27, 77824
    s_nop 0
    buffer_load_dwordx4 v8, s[8:11], s25 offen lds
    s_add_u32 s24, s24, 128
    s_add_u32 s25, s25, 128
    s_mov_b32 s16, s54
    s_mov_b32 s17, s55
    s_mov_b32 s18, 1024
    s_mov_b32 s19, 0x00020000
    v_lshrrev_b32 v60, 5, v1
    v_lshlrev_b32 v60, 3, v60
    s_mul_i32 s30, s62, 32
    s_add_u32 s30, s30, s28
    s_lshl_b32 s35, s30, 1
    buffer_load_dwordx2 v[62:63], v60, s[16:19], s35 offen offset:0
    buffer_load_dwordx2 v[64:65], v60, s[16:19], s35 offen offset:16
    buffer_load_dwordx2 v[66:67], v60, s[16:19], s35 offen offset:32
    buffer_load_dwordx2 v[68:69], v60, s[16:19], s35 offen offset:48
    v_and_b32 v70, 31, v1
    s_mul_i32 s30, s63, 32
    v_add_u32 v70, s30, v70
    s_mov_b32 s30, 1024
    v_mul_lo_u32 v70, v70, s30
    v_lshrrev_b32 v72, 5, v1
    v_lshlrev_b32 v72, 3, v72
    v_add_u32 v71, v70, v72
    v_add_u32 v70, v71, v72
    s_mul_i32 s33, s29, 1024
    s_mul_i32 s30, s62, 32
    s_add_u32 s30, s30, s28
    s_lshl_b32 s30, s30, 1
    s_add_u32 s33, s33, s30
    s_add_u32 s34, s33, 0
    buffer_load_dwordx2 v[74:75], v71, s[12:15], s34 offen offset:0
    buffer_load_dwordx2 v[76:77], v71, s[12:15], s34 offen offset:16
    buffer_load_dwordx2 v[78:79], v71, s[12:15], s34 offen offset:32
    buffer_load_dwordx2 v[80:81], v71, s[12:15], s34 offen offset:48
    s_waitcnt vmcnt(24)
    s_barrier
    ds_read_b128 v[28:31], v9 offset:0
    ds_read_b128 v[36:39], v17 offset:0
    ds_read_b128 v[32:35], v10 offset:0
    ds_read_b128 v[40:43], v18 offset:0
    s_waitcnt lgkmcnt(2)
    v_mfma_f32_32x32x16_bf16 v[44:59], v[28:31], v[36:39], 0
    ds_read_b128 v[28:31], v11 offset:0
    ds_read_b128 v[36:39], v19 offset:0
    s_waitcnt lgkmcnt(2)
    v_mfma_f32_32x32x16_bf16 v[44:59], v[32:35], v[40:43], v[44:59]
    ds_read_b128 v[32:35], v12 offset:0
    ds_read_b128 v[40:43], v20 offset:0
    s_waitcnt lgkmcnt(2)
    v_mfma_f32_32x32x16_bf16 v[44:59], v[28:31], v[36:39], v[44:59]
    s_waitcnt vmcnt(20)
    s_barrier
    ds_read_b128 v[28:31], v9 offset:16384
    ds_read_b128 v[36:39], v17 offset:16384
    s_waitcnt lgkmcnt(2)
    s_add_u32 m0, s27, 81920
    v_mfma_f32_32x32x16_bf16 v[44:59], v[32:35], v[40:43], v[44:59]
    buffer_load_dwordx4 v5, s[4:7], s24 offen lds
    s_add_u32 m0, s27, 86016
    s_nop 0
    buffer_load_dwordx4 v6, s[4:7], s24 offen lds
    s_add_u32 m0, s27, 90112
    s_nop 0
    buffer_load_dwordx4 v7, s[8:11], s25 offen lds
    s_add_u32 m0, s27, 94208
    s_nop 0
    buffer_load_dwordx4 v8, s[8:11], s25 offen lds
    s_add_u32 s24, s24, 128
    s_add_u32 s25, s25, 128
    ds_read_b128 v[32:35], v10 offset:16384
    ds_read_b128 v[40:43], v18 offset:16384
    s_waitcnt lgkmcnt(2)
    v_mfma_f32_32x32x16_bf16 v[44:59], v[28:31], v[36:39], v[44:59]
    ds_read_b128 v[28:31], v11 offset:16384
    ds_read_b128 v[36:39], v19 offset:16384
    s_waitcnt lgkmcnt(2)
    v_mfma_f32_32x32x16_bf16 v[44:59], v[32:35], v[40:43], v[44:59]
    ds_read_b128 v[32:35], v12 offset:16384
    ds_read_b128 v[40:43], v20 offset:16384
    s_waitcnt lgkmcnt(2)
    v_mfma_f32_32x32x16_bf16 v[44:59], v[28:31], v[36:39], v[44:59]
    s_waitcnt vmcnt(20)
    s_barrier
    ds_read_b128 v[28:31], v9 offset:32768
    ds_read_b128 v[36:39], v17 offset:32768
    s_waitcnt lgkmcnt(2)
    s_mov_b32 m0, s27
    v_mfma_f32_32x32x16_bf16 v[44:59], v[32:35], v[40:43], v[44:59]
    buffer_load_dwordx4 v5, s[4:7], s24 offen lds
    s_add_u32 m0, s27, 4096
    s_nop 0
    buffer_load_dwordx4 v6, s[4:7], s24 offen lds
    s_add_u32 m0, s27, 8192
    s_nop 0
    buffer_load_dwordx4 v7, s[8:11], s25 offen lds
    s_add_u32 m0, s27, 12288
    s_nop 0
    buffer_load_dwordx4 v8, s[8:11], s25 offen lds
    s_add_u32 s24, s24, 128
    s_add_u32 s25, s25, 128
    s_waitcnt vmcnt(8)
    v_lshlrev_b32 v82, 16, v62
    v_and_b32 v83, 0xffff0000, v62
    v_lshlrev_b32 v84, 16, v63
    v_and_b32 v85, 0xffff0000, v63
    v_lshlrev_b32 v86, 16, v64
    v_and_b32 v87, 0xffff0000, v64
    v_lshlrev_b32 v88, 16, v65
    v_and_b32 v89, 0xffff0000, v65
    v_lshlrev_b32 v90, 16, v66
    v_and_b32 v91, 0xffff0000, v66
    v_lshlrev_b32 v92, 16, v67
    v_and_b32 v93, 0xffff0000, v67
    v_lshlrev_b32 v94, 16, v68
    v_and_b32 v95, 0xffff0000, v68
    v_lshlrev_b32 v96, 16, v69
    v_and_b32 v97, 0xffff0000, v69
    v_lshlrev_b32 v98, 16, v74
    v_and_b32 v99, 0xffff0000, v74
    v_lshlrev_b32 v100, 16, v75
    v_and_b32 v101, 0xffff0000, v75
    v_lshlrev_b32 v102, 16, v76
    v_and_b32 v103, 0xffff0000, v76
    v_lshlrev_b32 v104, 16, v77
    v_and_b32 v105, 0xffff0000, v77
    v_lshlrev_b32 v106, 16, v78
    v_and_b32 v107, 0xffff0000, v78
    v_lshlrev_b32 v108, 16, v79
    v_and_b32 v109, 0xffff0000, v79
    v_lshlrev_b32 v110, 16, v80
    v_and_b32 v111, 0xffff0000, v80
    v_lshlrev_b32 v112, 16, v81
    v_and_b32 v113, 0xffff0000, v81
    ds_read_b128 v[32:35], v10 offset:32768
    ds_read_b128 v[40:43], v18 offset:32768
    s_waitcnt lgkmcnt(2)
    v_mfma_f32_32x32x16_bf16 v[44:59], v[28:31], v[36:39], v[44:59]
    ds_read_b128 v[28:31], v11 offset:32768
    ds_read_b128 v[36:39], v19 offset:32768
    s_waitcnt lgkmcnt(2)
    v_mfma_f32_32x32x16_bf16 v[44:59], v[32:35], v[40:43], v[44:59]
    ds_read_b128 v[32:35], v12 offset:32768
    ds_read_b128 v[40:43], v20 offset:32768
    s_waitcnt lgkmcnt(2)
    v_mfma_f32_32x32x16_bf16 v[44:59], v[28:31], v[36:39], v[44:59]
    s_barrier
    ds_read_b128 v[28:31], v9 offset:49152
    ds_read_b128 v[36:39], v17 offset:49152
    s_waitcnt lgkmcnt(2)
    s_add_u32 m0, s27, 16384
    v_mfma_f32_32x32x16_bf16 v[44:59], v[32:35], v[40:43], v[44:59]
    buffer_load_dwordx4 v5, s[4:7], s24 offen lds
    s_add_u32 m0, s27, 20480
    s_nop 0
    buffer_load_dwordx4 v6, s[4:7], s24 offen lds
    s_add_u32 m0, s27, 24576
    s_nop 0
    buffer_load_dwordx4 v7, s[8:11], s25 offen lds
    s_add_u32 m0, s27, 28672
    s_nop 0
    buffer_load_dwordx4 v8, s[8:11], s25 offen lds
    s_add_u32 s24, s24, 128
    s_add_u32 s25, s25, 128
    ds_read_b128 v[32:35], v10 offset:49152
    ds_read_b128 v[40:43], v18 offset:49152
    s_waitcnt lgkmcnt(2)
    v_mfma_f32_32x32x16_bf16 v[44:59], v[28:31], v[36:39], v[44:59]
    ds_read_b128 v[28:31], v11 offset:49152
    ds_read_b128 v[36:39], v19 offset:49152
    s_waitcnt lgkmcnt(2)
    v_mfma_f32_32x32x16_bf16 v[44:59], v[32:35], v[40:43], v[44:59]
    ds_read_b128 v[32:35], v12 offset:49152
    ds_read_b128 v[40:43], v20 offset:49152
    s_waitcnt lgkmcnt(2)
    v_mfma_f32_32x32x16_bf16 v[44:59], v[28:31], v[36:39], v[44:59]
    s_barrier
    ds_read_b128 v[28:31], v13 offset:0
    ds_read_b128 v[36:39], v21 offset:0
    s_waitcnt lgkmcnt(2)
    s_add_u32 m0, s27, 32768
    v_mfma_f32_32x32x16_bf16 v[44:59], v[32:35], v[40:43], v[44:59]
    buffer_load_dwordx4 v5, s[4:7], s24 offen lds
    s_add_u32 m0, s27, 36864
    s_nop 0
    buffer_load_dwordx4 v6, s[4:7], s24 offen lds
    s_add_u32 m0, s27, 40960
    s_nop 0
    buffer_load_dwordx4 v7, s[8:11], s25 offen lds
    s_add_u32 m0, s27, 45056
    s_nop 0
    buffer_load_dwordx4 v8, s[8:11], s25 offen lds
    s_add_u32 s24, s24, 128
    s_add_u32 s25, s25, 128
    ds_read_b128 v[32:35], v14 offset:0
    ds_read_b128 v[40:43], v22 offset:0
    s_waitcnt lgkmcnt(2)
    v_mfma_f32_32x32x16_bf16 v[44:59], v[28:31], v[36:39], v[44:59]
    ds_read_b128 v[28:31], v15 offset:0
    ds_read_b128 v[36:39], v23 offset:0
    s_waitcnt lgkmcnt(2)
    v_mfma_f32_32x32x16_bf16 v[44:59], v[32:35], v[40:43], v[44:59]
    ds_read_b128 v[32:35], v16 offset:0
    ds_read_b128 v[40:43], v24 offset:0
    s_waitcnt lgkmcnt(2)
    v_mfma_f32_32x32x16_bf16 v[44:59], v[28:31], v[36:39], v[44:59]
    s_waitcnt vmcnt(12)
    s_barrier
    ds_read_b128 v[28:31], v13 offset:16384
    ds_read_b128 v[36:39], v21 offset:16384
    s_waitcnt lgkmcnt(2)
    s_add_u32 m0, s27, 49152
    v_mfma_f32_32x32x16_bf16 v[44:59], v[32:35], v[40:43], v[44:59]
    buffer_load_dwordx4 v5, s[4:7], s24 offen lds
    s_add_u32 m0, s27, 53248
    s_nop 0
    buffer_load_dwordx4 v6, s[4:7], s24 offen lds
    s_add_u32 m0, s27, 57344
    s_nop 0
    buffer_load_dwordx4 v7, s[8:11], s25 offen lds
    s_add_u32 m0, s27, 61440
    s_nop 0
    buffer_load_dwordx4 v8, s[8:11], s25 offen lds
    s_add_u32 s24, s24, 128
    s_add_u32 s25, s25, 128
    ds_read_b128 v[32:35], v14 offset:16384
    ds_read_b128 v[40:43], v22 offset:16384
    s_waitcnt lgkmcnt(2)
    v_mfma_f32_32x32x16_bf16 v[44:59], v[28:31], v[36:39], v[44:59]
    ds_read_b128 v[28:31], v15 offset:16384
    ds_read_b128 v[36:39], v23 offset:16384
    s_waitcnt lgkmcnt(2)
    v_mfma_f32_32x32x16_bf16 v[44:59], v[32:35], v[40:43], v[44:59]
    ds_read_b128 v[32:35], v16 offset:16384
    ds_read_b128 v[40:43], v24 offset:16384
    s_waitcnt lgkmcnt(2)
    v_mfma_f32_32x32x16_bf16 v[44:59], v[28:31], v[36:39], v[44:59]
    s_waitcnt vmcnt(12)
    s_barrier
    ds_read_b128 v[28:31], v9 offset:0
    ds_read_b128 v[36:39], v17 offset:0
    s_waitcnt lgkmcnt(2)
    s_add_u32 m0, s27, 65536
    v_mfma_f32_32x32x16_bf16 v[44:59], v[32:35], v[40:43], v[44:59]
    buffer_load_dwordx4 v5, s[4:7], s24 offen lds
    s_add_u32 m0, s27, 69632
    s_nop 0
    buffer_load_dwordx4 v6, s[4:7], s24 offen lds
    s_add_u32 m0, s27, 73728
    s_nop 0
    buffer_load_dwordx4 v7, s[8:11], s25 offen lds
    s_add_u32 m0, s27, 77824
    s_nop 0
    buffer_load_dwordx4 v8, s[8:11], s25 offen lds
    s_add_u32 s24, s24, 128
    s_add_u32 s25, s25, 128
    ds_read_b128 v[32:35], v10 offset:0
    ds_read_b128 v[40:43], v18 offset:0
    s_waitcnt lgkmcnt(2)
    v_mfma_f32_32x32x16_bf16 v[44:59], v[28:31], v[36:39], v[44:59]
    ds_read_b128 v[28:31], v11 offset:0
    ds_read_b128 v[36:39], v19 offset:0
    s_waitcnt lgkmcnt(2)
    v_mfma_f32_32x32x16_bf16 v[44:59], v[32:35], v[40:43], v[44:59]
    ds_read_b128 v[32:35], v12 offset:0
    ds_read_b128 v[40:43], v20 offset:0
    s_waitcnt lgkmcnt(2)
    v_mfma_f32_32x32x16_bf16 v[44:59], v[28:31], v[36:39], v[44:59]
    s_waitcnt vmcnt(12)
    s_barrier
    ds_read_b128 v[28:31], v9 offset:16384
    ds_read_b128 v[36:39], v17 offset:16384
    s_waitcnt lgkmcnt(2)
    s_add_u32 m0, s27, 81920
    v_mfma_f32_32x32x16_bf16 v[44:59], v[32:35], v[40:43], v[44:59]
    buffer_load_dwordx4 v5, s[4:7], s24 offen lds
    s_add_u32 m0, s27, 86016
    s_nop 0
    buffer_load_dwordx4 v6, s[4:7], s24 offen lds
    s_add_u32 m0, s27, 90112
    s_nop 0
    buffer_load_dwordx4 v7, s[8:11], s25 offen lds
    s_add_u32 m0, s27, 94208
    s_nop 0
    buffer_load_dwordx4 v8, s[8:11], s25 offen lds
    s_add_u32 s24, s24, 128
    s_add_u32 s25, s25, 128
    ds_read_b128 v[32:35], v10 offset:16384
    ds_read_b128 v[40:43], v18 offset:16384
    s_waitcnt lgkmcnt(2)
    v_mfma_f32_32x32x16_bf16 v[44:59], v[28:31], v[36:39], v[44:59]
    ds_read_b128 v[28:31], v11 offset:16384
    ds_read_b128 v[36:39], v19 offset:16384
    s_waitcnt lgkmcnt(2)
    v_mfma_f32_32x32x16_bf16 v[44:59], v[32:35], v[40:43], v[44:59]
    ds_read_b128 v[32:35], v12 offset:16384
    ds_read_b128 v[40:43], v20 offset:16384
    s_waitcnt lgkmcnt(2)
    v_mfma_f32_32x32x16_bf16 v[44:59], v[28:31], v[36:39], v[44:59]
    s_waitcnt vmcnt(12)
    s_barrier
    ds_read_b128 v[28:31], v9 offset:32768
    ds_read_b128 v[36:39], v17 offset:32768
    s_waitcnt lgkmcnt(2)
    s_mov_b32 m0, s27
    v_mfma_f32_32x32x16_bf16 v[44:59], v[32:35], v[40:43], v[44:59]
    buffer_load_dwordx4 v5, s[4:7], s24 offen lds
    s_add_u32 m0, s27, 4096
    s_nop 0
    buffer_load_dwordx4 v6, s[4:7], s24 offen lds
    s_add_u32 m0, s27, 8192
    s_nop 0
    buffer_load_dwordx4 v7, s[8:11], s25 offen lds
    s_add_u32 m0, s27, 12288
    s_nop 0
    buffer_load_dwordx4 v8, s[8:11], s25 offen lds
    s_add_u32 s24, s24, 128
    s_add_u32 s25, s25, 128
    ds_read_b128 v[32:35], v10 offset:32768
    ds_read_b128 v[40:43], v18 offset:32768
    s_waitcnt lgkmcnt(2)
    v_mfma_f32_32x32x16_bf16 v[44:59], v[28:31], v[36:39], v[44:59]
    ds_read_b128 v[28:31], v11 offset:32768
    ds_read_b128 v[36:39], v19 offset:32768
    s_waitcnt lgkmcnt(2)
    v_mfma_f32_32x32x16_bf16 v[44:59], v[32:35], v[40:43], v[44:59]
    ds_read_b128 v[32:35], v12 offset:32768
    ds_read_b128 v[40:43], v20 offset:32768
    s_waitcnt lgkmcnt(2)
    v_mfma_f32_32x32x16_bf16 v[44:59], v[28:31], v[36:39], v[44:59]
    s_waitcnt vmcnt(12)
    s_barrier
    ds_read_b128 v[28:31], v9 offset:49152
    ds_read_b128 v[36:39], v17 offset:49152
    s_waitcnt lgkmcnt(2)
    s_add_u32 m0, s27, 16384
    v_mfma_f32_32x32x16_bf16 v[44:59], v[32:35], v[40:43], v[44:59]
    buffer_load_dwordx4 v5, s[4:7], s24 offen lds
    s_add_u32 m0, s27, 20480
    s_nop 0
    buffer_load_dwordx4 v6, s[4:7], s24 offen lds
    s_add_u32 m0, s27, 24576
    s_nop 0
    buffer_load_dwordx4 v7, s[8:11], s25 offen lds
    s_add_u32 m0, s27, 28672
    s_nop 0
    buffer_load_dwordx4 v8, s[8:11], s25 offen lds
    s_add_u32 s24, s24, 128
    s_add_u32 s25, s25, 128
    ds_read_b128 v[32:35], v10 offset:49152
    ds_read_b128 v[40:43], v18 offset:49152
    s_waitcnt lgkmcnt(2)
    v_mfma_f32_32x32x16_bf16 v[44:59], v[28:31], v[36:39], v[44:59]
    ds_read_b128 v[28:31], v11 offset:49152
    ds_read_b128 v[36:39], v19 offset:49152
    s_waitcnt lgkmcnt(2)
    v_mfma_f32_32x32x16_bf16 v[44:59], v[32:35], v[40:43], v[44:59]
    ds_read_b128 v[32:35], v12 offset:49152
    ds_read_b128 v[40:43], v20 offset:49152
    s_waitcnt lgkmcnt(2)
    v_mfma_f32_32x32x16_bf16 v[44:59], v[28:31], v[36:39], v[44:59]
    s_waitcnt vmcnt(12)
    s_barrier
    ds_read_b128 v[28:31], v13 offset:0
    ds_read_b128 v[36:39], v21 offset:0
    s_waitcnt lgkmcnt(2)
    s_add_u32 m0, s27, 32768
    v_mfma_f32_32x32x16_bf16 v[44:59], v[32:35], v[40:43], v[44:59]
    buffer_load_dwordx4 v5, s[4:7], s24 offen lds
    s_add_u32 m0, s27, 36864
    s_nop 0
    buffer_load_dwordx4 v6, s[4:7], s24 offen lds
    s_add_u32 m0, s27, 40960
    s_nop 0
    buffer_load_dwordx4 v7, s[8:11], s25 offen lds
    s_add_u32 m0, s27, 45056
    s_nop 0
    buffer_load_dwordx4 v8, s[8:11], s25 offen lds
    s_add_u32 s24, s24, 128
    s_add_u32 s25, s25, 128
    ds_read_b128 v[32:35], v14 offset:0
    ds_read_b128 v[40:43], v22 offset:0
    s_waitcnt lgkmcnt(2)
    v_mfma_f32_32x32x16_bf16 v[44:59], v[28:31], v[36:39], v[44:59]
    ds_read_b128 v[28:31], v15 offset:0
    ds_read_b128 v[36:39], v23 offset:0
    s_waitcnt lgkmcnt(2)
    v_mfma_f32_32x32x16_bf16 v[44:59], v[32:35], v[40:43], v[44:59]
    ds_read_b128 v[32:35], v16 offset:0
    ds_read_b128 v[40:43], v24 offset:0
    s_waitcnt lgkmcnt(2)
    v_mfma_f32_32x32x16_bf16 v[44:59], v[28:31], v[36:39], v[44:59]
    s_waitcnt vmcnt(12)
    s_barrier
    ds_read_b128 v[28:31], v13 offset:16384
    ds_read_b128 v[36:39], v21 offset:16384
    s_waitcnt lgkmcnt(2)
    s_add_u32 m0, s27, 49152
    v_mfma_f32_32x32x16_bf16 v[44:59], v[32:35], v[40:43], v[44:59]
    buffer_load_dwordx4 v5, s[4:7], s24 offen lds
    s_add_u32 m0, s27, 53248
    s_nop 0
    buffer_load_dwordx4 v6, s[4:7], s24 offen lds
    s_add_u32 m0, s27, 57344
    s_nop 0
    buffer_load_dwordx4 v7, s[8:11], s25 offen lds
    s_add_u32 m0, s27, 61440
    s_nop 0
    buffer_load_dwordx4 v8, s[8:11], s25 offen lds
    s_add_u32 s24, s24, 128
    s_add_u32 s25, s25, 128
    ds_read_b128 v[32:35], v14 offset:16384
    ds_read_b128 v[40:43], v22 offset:16384
    s_waitcnt lgkmcnt(2)
    v_mfma_f32_32x32x16_bf16 v[44:59], v[28:31], v[36:39], v[44:59]
    ds_read_b128 v[28:31], v15 offset:16384
    ds_read_b128 v[36:39], v23 offset:16384
    s_waitcnt lgkmcnt(2)
    v_mfma_f32_32x32x16_bf16 v[44:59], v[32:35], v[40:43], v[44:59]
    ds_read_b128 v[32:35], v16 offset:16384
    ds_read_b128 v[40:43], v24 offset:16384
    s_waitcnt lgkmcnt(2)
    v_mfma_f32_32x32x16_bf16 v[44:59], v[28:31], v[36:39], v[44:59]
    s_waitcnt vmcnt(12)
    s_barrier
    ds_read_b128 v[28:31], v9 offset:0
    ds_read_b128 v[36:39], v17 offset:0
    s_waitcnt lgkmcnt(2)
    s_add_u32 m0, s27, 65536
    v_mfma_f32_32x32x16_bf16 v[44:59], v[32:35], v[40:43], v[44:59]
    buffer_load_dwordx4 v5, s[4:7], s24 offen lds
    s_add_u32 m0, s27, 69632
    s_nop 0
    buffer_load_dwordx4 v6, s[4:7], s24 offen lds
    s_add_u32 m0, s27, 73728
    s_nop 0
    buffer_load_dwordx4 v7, s[8:11], s25 offen lds
    s_add_u32 m0, s27, 77824
    s_nop 0
    buffer_load_dwordx4 v8, s[8:11], s25 offen lds
    s_add_u32 s24, s24, 128
    s_add_u32 s25, s25, 128
    ds_read_b128 v[32:35], v10 offset:0
    ds_read_b128 v[40:43], v18 offset:0
    s_waitcnt lgkmcnt(2)
    v_mfma_f32_32x32x16_bf16 v[44:59], v[28:31], v[36:39], v[44:59]
    ds_read_b128 v[28:31], v11 offset:0
    ds_read_b128 v[36:39], v19 offset:0
    s_waitcnt lgkmcnt(2)
    v_mfma_f32_32x32x16_bf16 v[44:59], v[32:35], v[40:43], v[44:59]
    ds_read_b128 v[32:35], v12 offset:0
    ds_read_b128 v[40:43], v20 offset:0
    s_waitcnt lgkmcnt(2)
    v_mfma_f32_32x32x16_bf16 v[44:59], v[28:31], v[36:39], v[44:59]
    s_waitcnt vmcnt(12)
    s_barrier
    ds_read_b128 v[28:31], v9 offset:16384
    ds_read_b128 v[36:39], v17 offset:16384
    s_waitcnt lgkmcnt(2)
    s_add_u32 m0, s27, 81920
    v_mfma_f32_32x32x16_bf16 v[44:59], v[32:35], v[40:43], v[44:59]
    buffer_load_dwordx4 v5, s[4:7], s24 offen lds
    s_add_u32 m0, s27, 86016
    s_nop 0
    buffer_load_dwordx4 v6, s[4:7], s24 offen lds
    s_add_u32 m0, s27, 90112
    s_nop 0
    buffer_load_dwordx4 v7, s[8:11], s25 offen lds
    s_add_u32 m0, s27, 94208
    s_nop 0
    buffer_load_dwordx4 v8, s[8:11], s25 offen lds
    s_add_u32 s24, s24, 128
    s_add_u32 s25, s25, 128
    ds_read_b128 v[32:35], v10 offset:16384
    ds_read_b128 v[40:43], v18 offset:16384
    s_waitcnt lgkmcnt(2)
    v_mfma_f32_32x32x16_bf16 v[44:59], v[28:31], v[36:39], v[44:59]
    ds_read_b128 v[28:31], v11 offset:16384
    ds_read_b128 v[36:39], v19 offset:16384
    s_waitcnt lgkmcnt(2)
    v_mfma_f32_32x32x16_bf16 v[44:59], v[32:35], v[40:43], v[44:59]
    ds_read_b128 v[32:35], v12 offset:16384
    ds_read_b128 v[40:43], v20 offset:16384
    s_waitcnt lgkmcnt(2)
    v_mfma_f32_32x32x16_bf16 v[44:59], v[28:31], v[36:39], v[44:59]
    s_waitcnt vmcnt(12)
    s_barrier
    ds_read_b128 v[28:31], v9 offset:32768
    ds_read_b128 v[36:39], v17 offset:32768
    s_waitcnt lgkmcnt(2)
    s_mov_b32 m0, s27
    v_mfma_f32_32x32x16_bf16 v[44:59], v[32:35], v[40:43], v[44:59]
    buffer_load_dwordx4 v5, s[4:7], s24 offen lds
    s_add_u32 m0, s27, 4096
    s_nop 0
    buffer_load_dwordx4 v6, s[4:7], s24 offen lds
    s_add_u32 m0, s27, 8192
    s_nop 0
    buffer_load_dwordx4 v7, s[8:11], s25 offen lds
    s_add_u32 m0, s27, 12288
    s_nop 0
    buffer_load_dwordx4 v8, s[8:11], s25 offen lds
    s_add_u32 s24, s24, 128
    s_add_u32 s25, s25, 128
    ds_read_b128 v[32:35], v10 offset:32768
    ds_read_b128 v[40:43], v18 offset:32768
    s_waitcnt lgkmcnt(2)
    v_mfma_f32_32x32x16_bf16 v[44:59], v[28:31], v[36:39], v[44:59]
    ds_read_b128 v[28:31], v11 offset:32768
    ds_read_b128 v[36:39], v19 offset:32768
    s_waitcnt lgkmcnt(2)
    v_mfma_f32_32x32x16_bf16 v[44:59], v[32:35], v[40:43], v[44:59]
    ds_read_b128 v[32:35], v12 offset:32768
    ds_read_b128 v[40:43], v20 offset:32768
    s_waitcnt lgkmcnt(2)
    v_mfma_f32_32x32x16_bf16 v[44:59], v[28:31], v[36:39], v[44:59]
    s_waitcnt vmcnt(12)
    s_barrier
    ds_read_b128 v[28:31], v9 offset:49152
    ds_read_b128 v[36:39], v17 offset:49152
    s_waitcnt lgkmcnt(2)
    s_add_u32 m0, s27, 16384
    v_mfma_f32_32x32x16_bf16 v[44:59], v[32:35], v[40:43], v[44:59]
    buffer_load_dwordx4 v5, s[4:7], s24 offen lds
    s_add_u32 m0, s27, 20480
    s_nop 0
    buffer_load_dwordx4 v6, s[4:7], s24 offen lds
    s_add_u32 m0, s27, 24576
    s_nop 0
    buffer_load_dwordx4 v7, s[8:11], s25 offen lds
    s_add_u32 m0, s27, 28672
    s_nop 0
    buffer_load_dwordx4 v8, s[8:11], s25 offen lds
    s_add_u32 s24, s24, 128
    s_add_u32 s25, s25, 128
    ds_read_b128 v[32:35], v10 offset:49152
    ds_read_b128 v[40:43], v18 offset:49152
    s_waitcnt lgkmcnt(2)
    v_mfma_f32_32x32x16_bf16 v[44:59], v[28:31], v[36:39], v[44:59]
    ds_read_b128 v[28:31], v11 offset:49152
    ds_read_b128 v[36:39], v19 offset:49152
    s_waitcnt lgkmcnt(2)
    v_mfma_f32_32x32x16_bf16 v[44:59], v[32:35], v[40:43], v[44:59]
    ds_read_b128 v[32:35], v12 offset:49152
    ds_read_b128 v[40:43], v20 offset:49152
    s_waitcnt lgkmcnt(2)
    v_mfma_f32_32x32x16_bf16 v[44:59], v[28:31], v[36:39], v[44:59]
    s_waitcnt vmcnt(12)
    s_barrier
    ds_read_b128 v[28:31], v13 offset:0
    ds_read_b128 v[36:39], v21 offset:0
    s_waitcnt lgkmcnt(2)
    s_add_u32 m0, s27, 32768
    v_mfma_f32_32x32x16_bf16 v[44:59], v[32:35], v[40:43], v[44:59]
    buffer_load_dwordx4 v5, s[4:7], s24 offen lds
    s_add_u32 m0, s27, 36864
    s_nop 0
    buffer_load_dwordx4 v6, s[4:7], s24 offen lds
    s_add_u32 m0, s27, 40960
    s_nop 0
    buffer_load_dwordx4 v7, s[8:11], s25 offen lds
    s_add_u32 m0, s27, 45056
    s_nop 0
    buffer_load_dwordx4 v8, s[8:11], s25 offen lds
    s_add_u32 s24, s24, 128
    s_add_u32 s25, s25, 128
    ds_read_b128 v[32:35], v14 offset:0
    ds_read_b128 v[40:43], v22 offset:0
    s_waitcnt lgkmcnt(2)
    v_mfma_f32_32x32x16_bf16 v[44:59], v[28:31], v[36:39], v[44:59]
    ds_read_b128 v[28:31], v15 offset:0
    ds_read_b128 v[36:39], v23 offset:0
    s_waitcnt lgkmcnt(2)
    v_mfma_f32_32x32x16_bf16 v[44:59], v[32:35], v[40:43], v[44:59]
    ds_read_b128 v[32:35], v16 offset:0
    ds_read_b128 v[40:43], v24 offset:0
    s_waitcnt lgkmcnt(2)
    v_mfma_f32_32x32x16_bf16 v[44:59], v[28:31], v[36:39], v[44:59]
    s_waitcnt vmcnt(12)
    s_barrier
    ds_read_b128 v[28:31], v13 offset:16384
    ds_read_b128 v[36:39], v21 offset:16384
    s_waitcnt lgkmcnt(2)
    s_add_u32 m0, s27, 49152
    v_mfma_f32_32x32x16_bf16 v[44:59], v[32:35], v[40:43], v[44:59]
    buffer_load_dwordx4 v5, s[4:7], s24 offen lds
    s_add_u32 m0, s27, 53248
    s_nop 0
    buffer_load_dwordx4 v6, s[4:7], s24 offen lds
    s_add_u32 m0, s27, 57344
    s_nop 0
    buffer_load_dwordx4 v7, s[8:11], s25 offen lds
    s_add_u32 m0, s27, 61440
    s_nop 0
    buffer_load_dwordx4 v8, s[8:11], s25 offen lds
    s_add_u32 s24, s24, 128
    s_add_u32 s25, s25, 128
    ds_read_b128 v[32:35], v14 offset:16384
    ds_read_b128 v[40:43], v22 offset:16384
    s_waitcnt lgkmcnt(2)
    v_mfma_f32_32x32x16_bf16 v[44:59], v[28:31], v[36:39], v[44:59]
    ds_read_b128 v[28:31], v15 offset:16384
    ds_read_b128 v[36:39], v23 offset:16384
    s_waitcnt lgkmcnt(2)
    v_mfma_f32_32x32x16_bf16 v[44:59], v[32:35], v[40:43], v[44:59]
    ds_read_b128 v[32:35], v16 offset:16384
    ds_read_b128 v[40:43], v24 offset:16384
    s_waitcnt lgkmcnt(2)
    v_mfma_f32_32x32x16_bf16 v[44:59], v[28:31], v[36:39], v[44:59]
    s_waitcnt vmcnt(12)
    s_barrier
    ds_read_b128 v[28:31], v9 offset:0
    ds_read_b128 v[36:39], v17 offset:0
    s_waitcnt lgkmcnt(2)
    s_add_u32 m0, s27, 65536
    v_mfma_f32_32x32x16_bf16 v[44:59], v[32:35], v[40:43], v[44:59]
    buffer_load_dwordx4 v5, s[4:7], s24 offen lds
    s_add_u32 m0, s27, 69632
    s_nop 0
    buffer_load_dwordx4 v6, s[4:7], s24 offen lds
    s_add_u32 m0, s27, 73728
    s_nop 0
    buffer_load_dwordx4 v7, s[8:11], s25 offen lds
    s_add_u32 m0, s27, 77824
    s_nop 0
    buffer_load_dwordx4 v8, s[8:11], s25 offen lds
    s_add_u32 s24, s24, 128
    s_add_u32 s25, s25, 128
    ds_read_b128 v[32:35], v10 offset:0
    ds_read_b128 v[40:43], v18 offset:0
    s_waitcnt lgkmcnt(2)
    v_mfma_f32_32x32x16_bf16 v[44:59], v[28:31], v[36:39], v[44:59]
    ds_read_b128 v[28:31], v11 offset:0
    ds_read_b128 v[36:39], v19 offset:0
    s_waitcnt lgkmcnt(2)
    v_mfma_f32_32x32x16_bf16 v[44:59], v[32:35], v[40:43], v[44:59]
    ds_read_b128 v[32:35], v12 offset:0
    ds_read_b128 v[40:43], v20 offset:0
    s_waitcnt lgkmcnt(2)
    v_mfma_f32_32x32x16_bf16 v[44:59], v[28:31], v[36:39], v[44:59]
    s_waitcnt vmcnt(12)
    s_barrier
    ds_read_b128 v[28:31], v9 offset:16384
    ds_read_b128 v[36:39], v17 offset:16384
    s_waitcnt lgkmcnt(2)
    s_add_u32 m0, s27, 81920
    v_mfma_f32_32x32x16_bf16 v[44:59], v[32:35], v[40:43], v[44:59]
    buffer_load_dwordx4 v5, s[4:7], s24 offen lds
    s_add_u32 m0, s27, 86016
    s_nop 0
    buffer_load_dwordx4 v6, s[4:7], s24 offen lds
    s_add_u32 m0, s27, 90112
    s_nop 0
    buffer_load_dwordx4 v7, s[8:11], s25 offen lds
    s_add_u32 m0, s27, 94208
    s_nop 0
    buffer_load_dwordx4 v8, s[8:11], s25 offen lds
    s_add_u32 s24, s24, 128
    s_add_u32 s25, s25, 128
    ds_read_b128 v[32:35], v10 offset:16384
    ds_read_b128 v[40:43], v18 offset:16384
    s_waitcnt lgkmcnt(2)
    v_mfma_f32_32x32x16_bf16 v[44:59], v[28:31], v[36:39], v[44:59]
    ds_read_b128 v[28:31], v11 offset:16384
    ds_read_b128 v[36:39], v19 offset:16384
    s_waitcnt lgkmcnt(2)
    v_mfma_f32_32x32x16_bf16 v[44:59], v[32:35], v[40:43], v[44:59]
    ds_read_b128 v[32:35], v12 offset:16384
    ds_read_b128 v[40:43], v20 offset:16384
    s_waitcnt lgkmcnt(2)
    v_mfma_f32_32x32x16_bf16 v[44:59], v[28:31], v[36:39], v[44:59]
    s_waitcnt vmcnt(12)
    s_barrier
    ds_read_b128 v[28:31], v9 offset:32768
    ds_read_b128 v[36:39], v17 offset:32768
    s_waitcnt lgkmcnt(2)
    s_mov_b32 m0, s27
    v_mfma_f32_32x32x16_bf16 v[44:59], v[32:35], v[40:43], v[44:59]
    buffer_load_dwordx4 v5, s[4:7], s24 offen lds
    s_add_u32 m0, s27, 4096
    s_nop 0
    buffer_load_dwordx4 v6, s[4:7], s24 offen lds
    s_add_u32 m0, s27, 8192
    s_nop 0
    buffer_load_dwordx4 v7, s[8:11], s25 offen lds
    s_add_u32 m0, s27, 12288
    s_nop 0
    buffer_load_dwordx4 v8, s[8:11], s25 offen lds
    s_add_u32 s24, s24, 128
    s_add_u32 s25, s25, 128
    ds_read_b128 v[32:35], v10 offset:32768
    ds_read_b128 v[40:43], v18 offset:32768
    s_waitcnt lgkmcnt(2)
    v_mfma_f32_32x32x16_bf16 v[44:59], v[28:31], v[36:39], v[44:59]
    ds_read_b128 v[28:31], v11 offset:32768
    ds_read_b128 v[36:39], v19 offset:32768
    s_waitcnt lgkmcnt(2)
    v_mfma_f32_32x32x16_bf16 v[44:59], v[32:35], v[40:43], v[44:59]
    ds_read_b128 v[32:35], v12 offset:32768
    ds_read_b128 v[40:43], v20 offset:32768
    s_waitcnt lgkmcnt(2)
    v_mfma_f32_32x32x16_bf16 v[44:59], v[28:31], v[36:39], v[44:59]
    s_waitcnt vmcnt(12)
    s_barrier
    ds_read_b128 v[28:31], v9 offset:49152
    ds_read_b128 v[36:39], v17 offset:49152
    s_waitcnt lgkmcnt(2)
    s_add_u32 m0, s27, 16384
    v_mfma_f32_32x32x16_bf16 v[44:59], v[32:35], v[40:43], v[44:59]
    buffer_load_dwordx4 v5, s[4:7], s24 offen lds
    s_add_u32 m0, s27, 20480
    s_nop 0
    buffer_load_dwordx4 v6, s[4:7], s24 offen lds
    s_add_u32 m0, s27, 24576
    s_nop 0
    buffer_load_dwordx4 v7, s[8:11], s25 offen lds
    s_add_u32 m0, s27, 28672
    s_nop 0
    buffer_load_dwordx4 v8, s[8:11], s25 offen lds
    s_add_u32 s24, s24, 128
    s_add_u32 s25, s25, 128
    ds_read_b128 v[32:35], v10 offset:49152
    ds_read_b128 v[40:43], v18 offset:49152
    s_waitcnt lgkmcnt(2)
    v_mfma_f32_32x32x16_bf16 v[44:59], v[28:31], v[36:39], v[44:59]
    ds_read_b128 v[28:31], v11 offset:49152
    ds_read_b128 v[36:39], v19 offset:49152
    s_waitcnt lgkmcnt(2)
    v_mfma_f32_32x32x16_bf16 v[44:59], v[32:35], v[40:43], v[44:59]
    ds_read_b128 v[32:35], v12 offset:49152
    ds_read_b128 v[40:43], v20 offset:49152
    s_waitcnt lgkmcnt(2)
    v_mfma_f32_32x32x16_bf16 v[44:59], v[28:31], v[36:39], v[44:59]
    s_waitcnt vmcnt(12)
    s_barrier
    ds_read_b128 v[28:31], v13 offset:0
    ds_read_b128 v[36:39], v21 offset:0
    s_waitcnt lgkmcnt(2)
    s_add_u32 m0, s27, 32768
    v_mfma_f32_32x32x16_bf16 v[44:59], v[32:35], v[40:43], v[44:59]
    buffer_load_dwordx4 v5, s[4:7], s24 offen lds
    s_add_u32 m0, s27, 36864
    s_nop 0
    buffer_load_dwordx4 v6, s[4:7], s24 offen lds
    s_add_u32 m0, s27, 40960
    s_nop 0
    buffer_load_dwordx4 v7, s[8:11], s25 offen lds
    s_add_u32 m0, s27, 45056
    s_nop 0
    buffer_load_dwordx4 v8, s[8:11], s25 offen lds
    s_add_u32 s24, s24, 128
    s_add_u32 s25, s25, 128
    ds_read_b128 v[32:35], v14 offset:0
    ds_read_b128 v[40:43], v22 offset:0
    s_waitcnt lgkmcnt(2)
    v_mfma_f32_32x32x16_bf16 v[44:59], v[28:31], v[36:39], v[44:59]
    ds_read_b128 v[28:31], v15 offset:0
    ds_read_b128 v[36:39], v23 offset:0
    s_waitcnt lgkmcnt(2)
    v_mfma_f32_32x32x16_bf16 v[44:59], v[32:35], v[40:43], v[44:59]
    ds_read_b128 v[32:35], v16 offset:0
    ds_read_b128 v[40:43], v24 offset:0
    s_waitcnt lgkmcnt(2)
    v_mfma_f32_32x32x16_bf16 v[44:59], v[28:31], v[36:39], v[44:59]
    s_waitcnt vmcnt(12)
    s_barrier
    ds_read_b128 v[28:31], v13 offset:16384
    ds_read_b128 v[36:39], v21 offset:16384
    s_waitcnt lgkmcnt(2)
    s_add_u32 m0, s27, 49152
    v_mfma_f32_32x32x16_bf16 v[44:59], v[32:35], v[40:43], v[44:59]
    buffer_load_dwordx4 v5, s[4:7], s24 offen lds
    s_add_u32 m0, s27, 53248
    s_nop 0
    buffer_load_dwordx4 v6, s[4:7], s24 offen lds
    s_add_u32 m0, s27, 57344
    s_nop 0
    buffer_load_dwordx4 v7, s[8:11], s25 offen lds
    s_add_u32 m0, s27, 61440
    s_nop 0
    buffer_load_dwordx4 v8, s[8:11], s25 offen lds
    s_add_u32 s24, s24, 128
    s_add_u32 s25, s25, 128
    ds_read_b128 v[32:35], v14 offset:16384
    ds_read_b128 v[40:43], v22 offset:16384
    s_waitcnt lgkmcnt(2)
    v_mfma_f32_32x32x16_bf16 v[44:59], v[28:31], v[36:39], v[44:59]
    ds_read_b128 v[28:31], v15 offset:16384
    ds_read_b128 v[36:39], v23 offset:16384
    s_waitcnt lgkmcnt(2)
    v_mfma_f32_32x32x16_bf16 v[44:59], v[32:35], v[40:43], v[44:59]
    ds_read_b128 v[32:35], v16 offset:16384
    ds_read_b128 v[40:43], v24 offset:16384
    s_waitcnt lgkmcnt(2)
    v_mfma_f32_32x32x16_bf16 v[44:59], v[28:31], v[36:39], v[44:59]
    s_waitcnt vmcnt(12)
    s_barrier
    ds_read_b128 v[28:31], v9 offset:0
    ds_read_b128 v[36:39], v17 offset:0
    s_waitcnt lgkmcnt(2)
    v_mfma_f32_32x32x16_bf16 v[44:59], v[32:35], v[40:43], v[44:59]
    ds_read_b128 v[32:35], v10 offset:0
    ds_read_b128 v[40:43], v18 offset:0
    s_waitcnt lgkmcnt(2)
    v_mfma_f32_32x32x16_bf16 v[44:59], v[28:31], v[36:39], v[44:59]
    ds_read_b128 v[28:31], v11 offset:0
    ds_read_b128 v[36:39], v19 offset:0
    s_waitcnt lgkmcnt(2)
    v_mfma_f32_32x32x16_bf16 v[44:59], v[32:35], v[40:43], v[44:59]
    ds_read_b128 v[32:35], v12 offset:0
    ds_read_b128 v[40:43], v20 offset:0
    s_waitcnt lgkmcnt(2)
    v_mfma_f32_32x32x16_bf16 v[44:59], v[28:31], v[36:39], v[44:59]
    s_waitcnt vmcnt(8)
    s_barrier
    ds_read_b128 v[28:31], v9 offset:16384
    ds_read_b128 v[36:39], v17 offset:16384
    s_waitcnt lgkmcnt(2)
    v_mfma_f32_32x32x16_bf16 v[44:59], v[32:35], v[40:43], v[44:59]
    ds_read_b128 v[32:35], v10 offset:16384
    ds_read_b128 v[40:43], v18 offset:16384
    s_waitcnt lgkmcnt(2)
    v_mfma_f32_32x32x16_bf16 v[44:59], v[28:31], v[36:39], v[44:59]
    ds_read_b128 v[28:31], v11 offset:16384
    ds_read_b128 v[36:39], v19 offset:16384
    s_waitcnt lgkmcnt(2)
    v_mfma_f32_32x32x16_bf16 v[44:59], v[32:35], v[40:43], v[44:59]
    ds_read_b128 v[32:35], v12 offset:16384
    ds_read_b128 v[40:43], v20 offset:16384
    s_waitcnt lgkmcnt(2)
    v_mfma_f32_32x32x16_bf16 v[44:59], v[28:31], v[36:39], v[44:59]
    s_waitcnt vmcnt(4)
    s_barrier
    ds_read_b128 v[28:31], v9 offset:32768
    ds_read_b128 v[36:39], v17 offset:32768
    s_waitcnt lgkmcnt(2)
    v_mfma_f32_32x32x16_bf16 v[44:59], v[32:35], v[40:43], v[44:59]
    ds_read_b128 v[32:35], v10 offset:32768
    ds_read_b128 v[40:43], v18 offset:32768
    s_waitcnt lgkmcnt(2)
    v_mfma_f32_32x32x16_bf16 v[44:59], v[28:31], v[36:39], v[44:59]
    ds_read_b128 v[28:31], v11 offset:32768
    ds_read_b128 v[36:39], v19 offset:32768
    s_waitcnt lgkmcnt(2)
    v_mfma_f32_32x32x16_bf16 v[44:59], v[32:35], v[40:43], v[44:59]
    ds_read_b128 v[32:35], v12 offset:32768
    ds_read_b128 v[40:43], v20 offset:32768
    s_waitcnt lgkmcnt(2)
    v_mfma_f32_32x32x16_bf16 v[44:59], v[28:31], v[36:39], v[44:59]
    s_waitcnt vmcnt(0)
    s_barrier
    ds_read_b128 v[28:31], v9 offset:49152
    ds_read_b128 v[36:39], v17 offset:49152
    s_waitcnt lgkmcnt(2)
    v_mfma_f32_32x32x16_bf16 v[44:59], v[32:35], v[40:43], v[44:59]
    ds_read_b128 v[32:35], v10 offset:49152
    ds_read_b128 v[40:43], v18 offset:49152
    s_waitcnt lgkmcnt(2)
    v_mfma_f32_32x32x16_bf16 v[44:59], v[28:31], v[36:39], v[44:59]
    ds_read_b128 v[28:31], v11 offset:49152
    ds_read_b128 v[36:39], v19 offset:49152
    s_waitcnt lgkmcnt(2)
    v_mfma_f32_32x32x16_bf16 v[44:59], v[32:35], v[40:43], v[44:59]
    ds_read_b128 v[32:35], v12 offset:49152
    ds_read_b128 v[40:43], v20 offset:49152
    s_waitcnt lgkmcnt(2)
    v_mfma_f32_32x32x16_bf16 v[44:59], v[28:31], v[36:39], v[44:59]
    s_waitcnt lgkmcnt(0)
    v_mfma_f32_32x32x16_bf16 v[44:59], v[32:35], v[40:43], v[44:59]
    s_nop 15
    s_add_u32 s34, s33, 0
    v_cvt_pk_bf16_f32 v124, v44, v45
    v_cvt_pk_bf16_f32 v125, v46, v47
    v_lshlrev_b32 v126, 16, v124
    v_and_b32 v127, 0xffff0000, v124
    v_lshlrev_b32 v128, 16, v125
    v_and_b32 v129, 0xffff0000, v125
    v_pk_add_f32 v[126:127], v[126:127], v[82:83]
    v_pk_add_f32 v[128:129], v[128:129], v[84:85]
    v_cvt_pk_bf16_f32 v124, v126, v127
    v_cvt_pk_bf16_f32 v125, v128, v129
    v_lshlrev_b32 v126, 16, v124
    v_and_b32 v127, 0xffff0000, v124
    v_lshlrev_b32 v128, 16, v125
    v_and_b32 v129, 0xffff0000, v125
    v_pk_add_f32 v[126:127], v[126:127], v[98:99]
    v_pk_add_f32 v[128:129], v[128:129], v[100:101]
    v_cvt_pk_bf16_f32 v116, v126, v127
    v_cvt_pk_bf16_f32 v117, v128, v129
    v_cvt_pk_bf16_f32 v124, v48, v49
    v_cvt_pk_bf16_f32 v125, v50, v51
    v_lshlrev_b32 v126, 16, v124
    v_and_b32 v127, 0xffff0000, v124
    v_lshlrev_b32 v128, 16, v125
    v_and_b32 v129, 0xffff0000, v125
    v_pk_add_f32 v[126:127], v[126:127], v[86:87]
    v_pk_add_f32 v[128:129], v[128:129], v[88:89]
    v_cvt_pk_bf16_f32 v124, v126, v127
    v_cvt_pk_bf16_f32 v125, v128, v129
    v_lshlrev_b32 v126, 16, v124
    v_and_b32 v127, 0xffff0000, v124
    v_lshlrev_b32 v128, 16, v125
    v_and_b32 v129, 0xffff0000, v125
    v_pk_add_f32 v[126:127], v[126:127], v[102:103]
    v_pk_add_f32 v[128:129], v[128:129], v[104:105]
    v_cvt_pk_bf16_f32 v118, v126, v127
    v_cvt_pk_bf16_f32 v119, v128, v129
    s_nop 1
    v_permlane32_swap_b32 v116, v118
    v_permlane32_swap_b32 v117, v119
    buffer_store_dwordx4 v[116:119], v70, s[12:15], s34 offen offset:0
    v_cvt_pk_bf16_f32 v124, v52, v53
    v_cvt_pk_bf16_f32 v125, v54, v55
    v_lshlrev_b32 v126, 16, v124
    v_and_b32 v127, 0xffff0000, v124
    v_lshlrev_b32 v128, 16, v125
    v_and_b32 v129, 0xffff0000, v125
    v_pk_add_f32 v[126:127], v[126:127], v[90:91]
    v_pk_add_f32 v[128:129], v[128:129], v[92:93]
    v_cvt_pk_bf16_f32 v124, v126, v127
    v_cvt_pk_bf16_f32 v125, v128, v129
    v_lshlrev_b32 v126, 16, v124
    v_and_b32 v127, 0xffff0000, v124
    v_lshlrev_b32 v128, 16, v125
    v_and_b32 v129, 0xffff0000, v125
    v_pk_add_f32 v[126:127], v[126:127], v[106:107]
    v_pk_add_f32 v[128:129], v[128:129], v[108:109]
    v_cvt_pk_bf16_f32 v120, v126, v127
    v_cvt_pk_bf16_f32 v121, v128, v129
    v_cvt_pk_bf16_f32 v124, v56, v57
    v_cvt_pk_bf16_f32 v125, v58, v59
    v_lshlrev_b32 v126, 16, v124
    v_and_b32 v127, 0xffff0000, v124
    v_lshlrev_b32 v128, 16, v125
    v_and_b32 v129, 0xffff0000, v125
    v_pk_add_f32 v[126:127], v[126:127], v[94:95]
    v_pk_add_f32 v[128:129], v[128:129], v[96:97]
    v_cvt_pk_bf16_f32 v124, v126, v127
    v_cvt_pk_bf16_f32 v125, v128, v129
    v_lshlrev_b32 v126, 16, v124
    v_and_b32 v127, 0xffff0000, v124
    v_lshlrev_b32 v128, 16, v125
    v_and_b32 v129, 0xffff0000, v125
    v_pk_add_f32 v[126:127], v[126:127], v[110:111]
    v_pk_add_f32 v[128:129], v[128:129], v[112:113]
    v_cvt_pk_bf16_f32 v122, v126, v127
    v_cvt_pk_bf16_f32 v123, v128, v129
    s_nop 1
    v_permlane32_swap_b32 v120, v122
    v_permlane32_swap_b32 v121, v123
    buffer_store_dwordx4 v[120:123], v70, s[12:15], s34 offen offset:32
p4_kernel_end:
    s_endpgm
.section .rodata,"a"
.p2align 6
.amdhsa_kernel ln0_kernel
  .amdhsa_next_free_vgpr 104
  .amdhsa_next_free_sgpr 96
  .amdhsa_accum_offset 104
  .amdhsa_group_segment_fixed_size 0
  .amdhsa_kernarg_size 104
  .amdhsa_user_sgpr_count 2
  .amdhsa_user_sgpr_kernarg_segment_ptr 1
  .amdhsa_system_sgpr_workgroup_id_x 1
.end_amdhsa_kernel
.p2align 6
.amdhsa_kernel comb_kernel
  .amdhsa_next_free_vgpr 48
  .amdhsa_next_free_sgpr 96
  .amdhsa_accum_offset 48
  .amdhsa_group_segment_fixed_size 0
  .amdhsa_kernarg_size 104
  .amdhsa_user_sgpr_count 2
  .amdhsa_user_sgpr_kernarg_segment_ptr 1
  .amdhsa_system_sgpr_workgroup_id_x 1
.end_amdhsa_kernel
.p2align 6
.amdhsa_kernel ln_kernel
  .amdhsa_next_free_vgpr 32
  .amdhsa_next_free_sgpr 96
  .amdhsa_accum_offset 32
  .amdhsa_group_segment_fixed_size 0
  .amdhsa_kernarg_size 104
  .amdhsa_user_sgpr_count 2
  .amdhsa_user_sgpr_kernarg_segment_ptr 1
  .amdhsa_system_sgpr_workgroup_id_x 1
.end_amdhsa_kernel
.p2align 6
.amdhsa_kernel p1_kernel
  .amdhsa_next_free_vgpr 96
  .amdhsa_next_free_sgpr 96
  .amdhsa_accum_offset 96
  .amdhsa_group_segment_fixed_size 0
  .amdhsa_kernarg_size 104
  .amdhsa_user_sgpr_count 2
  .amdhsa_user_sgpr_kernarg_segment_ptr 1
  .amdhsa_system_sgpr_workgroup_id_x 1
.end_amdhsa_kernel
.p2align 6
.amdhsa_kernel p2_kernel
  .amdhsa_next_free_vgpr 96
  .amdhsa_next_free_sgpr 96
  .amdhsa_accum_offset 96
  .amdhsa_group_segment_fixed_size 0
  .amdhsa_kernarg_size 104
  .amdhsa_user_sgpr_count 2
  .amdhsa_user_sgpr_kernarg_segment_ptr 1
  .amdhsa_system_sgpr_workgroup_id_x 1
.end_amdhsa_kernel
.p2align 6
.amdhsa_kernel p3_kernel
  .amdhsa_next_free_vgpr 200
  .amdhsa_next_free_sgpr 96
  .amdhsa_accum_offset 200
  .amdhsa_group_segment_fixed_size 0
  .amdhsa_kernarg_size 104
  .amdhsa_user_sgpr_count 2
  .amdhsa_user_sgpr_kernarg_segment_ptr 1
  .amdhsa_system_sgpr_workgroup_id_x 1
.end_amdhsa_kernel
.p2align 6
.amdhsa_kernel p4_kernel
  .amdhsa_next_free_vgpr 136
  .amdhsa_next_free_sgpr 96
  .amdhsa_accum_offset 136
  .amdhsa_group_segment_fixed_size 0
  .amdhsa_kernarg_size 104
  .amdhsa_user_sgpr_count 2
  .amdhsa_user_sgpr_kernarg_segment_ptr 1
  .amdhsa_system_sgpr_workgroup_id_x 1
.end_amdhsa_kernel
```
